```python
import torch

def _softmax(x, axis=-1):
    return torch.softmax(x, dim=axis)
def _gelu(x):
    return torch.nn.functional.gelu(x, approximate="tanh")
def _silu(x):
    return torch.nn.functional.silu(x)
def _sigmoid(x):
    return torch.sigmoid(x)
def _layernorm(x, axis=-1, eps=1e-5):
    m = x.mean(dim=axis, keepdim=True)
    v = x.var(dim=axis, keepdim=True, unbiased=False)
    return (x - m) / torch.sqrt(v + eps)
def _scatter_add(tgt, idx, src, axis=0):
    return tgt.clone().index_add_(axis, idx, src)
def _segment_sum(src, seg, n):
    out = torch.zeros((n,) + src.shape[1:], dtype=src.dtype)
    return out.index_add_(0, seg, src)
def _pad(x, pw):
    flat = tuple(v for pair in reversed(pw) for v in pair)
    return torch.nn.functional.pad(x, flat)

kernel_name = 'concat_heads__ssm_conv_s4d__ssm_conv_h3__prompt'

def setup_inputs():

    _w = (lambda a: (lambda t: t.to(torch.bfloat16) if t.is_floating_point() else t)(torch.as_tensor(a)))
    def _A_setup():
        Bsz, L, D, N = 1, 2048, 448, 256
        return {
            "u": _w((lambda *s: torch.randn(*s, dtype=torch.bfloat16) * 0.05)(Bsz, L, D)),
            "log_A_real": _w((lambda *s: torch.randn(*s, dtype=torch.bfloat16) * 6.4)(D, N) * 0.5),
            "A_imag": _w((lambda *s: torch.randn(*s, dtype=torch.bfloat16) * 0.1)(D, N) * 3.14),
            "C_real": _w((lambda *s: torch.randn(*s, dtype=torch.bfloat16) * 0.2)(D, N) / N ** 0.5),
            "C_imag": _w((lambda *s: torch.randn(*s, dtype=torch.bfloat16) * 0.2)(D, N) / N ** 0.5),
            "log_dt": _w((lambda *s: torch.randn(*s, dtype=torch.bfloat16) * 0.1)(D) * 0.5 - 4.0),
            "D_skip": _w((lambda *s: torch.randn(*s, dtype=torch.bfloat16) * 0.1)(D)),
        }
    _A_in = _A_setup()

    def _B_setup():
        B, S, D = 1, 2048, 448
        ks = 4
        return {
            "q": _w((lambda *s: torch.randn(*s, dtype=torch.bfloat16) * 0.05)(B, S, D)),
            "k": _w((lambda *s: torch.randn(*s, dtype=torch.bfloat16) * 0.4)(B, S, D)),
            "v": _w((lambda *s: torch.randn(*s, dtype=torch.bfloat16) * 0.4)(B, S, D)),
            "shift_k": _w((lambda *s: torch.randn(*s, dtype=torch.bfloat16) * 0.4)(D, ks) * 0.5),
            "ssm_k": _w((lambda *s: torch.randn(*s, dtype=torch.bfloat16) * 0.4)(D, S) * (1.0 / S ** 0.5)),
            "ssm_D": _w((lambda *s: torch.randn(*s, dtype=torch.bfloat16) * 0.4)(D)),
        }
    _B_in = _B_setup()

    return {
        "A_u": _A_in["u"],
        "A_log_A_real": _A_in["log_A_real"],
        "A_A_imag": _A_in["A_imag"],
        "A_C_real": _A_in["C_real"],
        "A_C_imag": _A_in["C_imag"],
        "A_log_dt": _A_in["log_dt"],
        "A_D_skip": _A_in["D_skip"],
        "B_q": _B_in["q"],
        "B_k": _B_in["k"],
        "B_v": _B_in["v"],
        "B_shift_k": _B_in["shift_k"],
        "B_ssm_k": _B_in["ssm_k"],
        "B_ssm_D": _B_in["ssm_D"],
    }

def reference(A_u, A_log_A_real, A_A_imag, A_C_real, A_C_imag, A_log_dt, A_D_skip, B_q, B_k, B_v, B_shift_k, B_ssm_k, B_ssm_D):
    def _A_ref(u, log_A_real, A_imag, C_real, C_imag, log_dt, D_skip):
        L = u.shape[1]
        dt = torch.exp(log_dt)
        A = -torch.exp(log_A_real) + 1j * A_imag
        C = (C_real + 1j * C_imag) * dt[:, None]
        pos = (lambda x, dt: x.to(dt))(torch.arange(L), log_dt.dtype)
        P = torch.exp((A * dt[:, None])[:, :, None] * pos[None, None, :])
        K = 2.0 * torch.einsum("dn,dnl->dl", C, P).real
        L2 = 2 * L
        u_t = (lambda x, *d: x.permute(*d))(u, 0, 2, 1)
        Kf = (lambda x, *a, **k: torch.fft.rfft(x.float(), *a, **k))(K, L2)
        Uf = (lambda x, *a, **k: torch.fft.rfft(x.float(), *a, **k))(u_t, L2)
        y = (lambda x, *a, **k: torch.fft.irfft(x, *a, **k).to(torch.bfloat16))(Uf * Kf[None, :, :], L2)[:, :, :L]
        y = (lambda x, *d: x.permute(*d))(y, 0, 2, 1)
        return y + u * D_skip[None, None, :]

    def _B_ref(q, k, v, shift_k, ssm_k, ssm_D):
        B, S, D = q.shape
        ks = shift_k.shape[-1]
        k_pad = _pad(k, ((0, 0), (ks - 1, 0), (0, 0)))
        k_shift = torch.zeros_like(k)
        for t in range(ks):
            k_shift = k_shift + k_pad[:, t:t + S, :] * shift_k[:, ks - 1 - t][None, None, :]
        kv = k_shift * v
        L = 2 * S
        kv_pad = _pad(kv, ((0, 0), (0, S), (0, 0)))
        kf_pad = _pad(ssm_k, ((0, 0), (0, S)))
        kv_f = (lambda x, axes=(-2,-1): torch.fft.rfft2(x.float(), dim=axes))(kv_pad[:, None, :, :], axes=(1, 2))
        kf_f = (lambda x, axes=(-2,-1): torch.fft.rfft2(x.float(), dim=axes))(kf_pad[:, None, :], axes=(1, 2))
        kf_f = (lambda x, *d: x.permute(*d))(kf_f, 1, 2, 0)
        y_f = kv_f * kf_f[None, :, :, :]
        y = (lambda x, s, axes=(-2,-1): torch.fft.irfft2(x, s=s, dim=axes).to(torch.bfloat16))(y_f, (1, L), axes=(1, 2))[:, 0, :S, :]
        y = y + kv * ssm_D[None, None, :]
        return q * y

    a = _A_ref(A_u, A_log_A_real, A_A_imag, A_C_real, A_C_imag, A_log_dt, A_D_skip)
    b = _B_ref(B_q, B_k, B_v, B_shift_k, B_ssm_k, B_ssm_D)
    return torch.concatenate([a, b], axis=-1)
```

```asm
; @launch grid=(256,1,1) block=(512,1,1) lds=161344
.amdgcn_target "amdgcn-amd-amdhsa--gfx950"
.text
.globl concat_heads__ssm_conv_s4d__ssm_conv_h3__prompt_kernel
.p2align 8
.type concat_heads__ssm_conv_s4d__ssm_conv_h3__prompt_kernel,@function
concat_heads__ssm_conv_s4d__ssm_conv_h3__prompt_kernel:
    s_load_dwordx16 s[8:23], s[0:1], 0
    s_load_dwordx8 s[24:31], s[0:1], 64
    s_load_dwordx4 s[32:35], s[0:1], 96
    s_load_dwordx2 s[36:37], s[0:1], 120
    s_cmp_ge_u32 s2, 256
    s_cbranch_scc1 L_END
    s_and_b32 s7, s2, 7
    s_cmp_eq_u32 s7, 7
    s_cbranch_scc1 L_END
    v_lshrrev_b32 v1, 6, v0
    v_and_b32 v0, 63, v0
    v_readfirstlane_b32 s3, v1
    s_lshr_b32 s6, s2, 3
    s_lshr_b32 s38, s6, 4
    s_and_b32 s6, s6, 15
    s_lshl_b32 s5, s7, 6
    s_lshl_b32 s97, s6, 2
    s_add_u32 s5, s5, s97
    s_and_b32 s4, s3, 3
    s_lshr_b32 s39, s3, 2
    s_cmp_eq_u32 s3, 7
    s_cbranch_scc0 L_NOPF
    s_getpc_b64 s[98:99]
L_PC:
    s_lshl_b32 s55, s6, 11
    v_and_b32 v1, 15, v0
    v_lshl_add_u32 v1, v1, 7, s55
    v_min_u32 v1, L_LAST-4-L_PC, v1
    global_load_dword v248, v1, s[98:99]
L_NOPF:
    s_cmp_eq_u32 s38, 0
    s_cbranch_scc0 L_B0
    s_lshl_b32 s96, s5, 9
    s_lshl_b32 s97, s4, 9
    s_add_u32 s96, s96, s97
    s_lshl_b32 s97, s39, 8
    s_add_u32 s96, s96, s97
    v_lshl_add_u32 v1, v0, 2, s96
    s_lshl_b32 s55, s5, 1
    s_waitcnt lgkmcnt(0)
    global_load_dword v2, v1, s[10:11] nt
    global_load_dword v3, v1, s[12:13] nt
    global_load_dword v4, v1, s[14:15] nt
    global_load_dword v5, v1, s[16:17] nt
    s_load_dwordx2 s[72:73], s[18:19], s55
    s_load_dwordx2 s[74:75], s[20:21], s55
    s_mov_b32 s52, 0x05040100
    s_mov_b32 s53, 0x07060302
    s_mov_b32 s54, 0xffff
    s_cmp_eq_u32 s39, 0
    s_cbranch_scc0 L_A_PRO_H
    v_and_b32 v16, 15, v0
    v_lshrrev_b32 v17, 4, v0
    s_lshl_b32 s55, s6, 4
    s_lshl_b32 s97, s4, 2
    s_add_u32 s55, s55, s97
    v_add_u32 v17, s55, v17
    v_mul_u32_u24 v63, 7168, v17
    v_lshl_add_u32 v63, v16, 3, v63
    s_lshl_b32 s55, s7, 7
    v_add_u32 v63, s55, v63
    v_add_u32 v63, 3584, v63
    global_load_dwordx2 v[212:213], v63, s[8:9] offset:-3584 nt
    global_load_dwordx2 v[214:215], v63, s[8:9] offset:-2688 nt
    global_load_dwordx2 v[216:217], v63, s[8:9] offset:-1792 nt
    global_load_dwordx2 v[218:219], v63, s[8:9] offset:-896 nt
    global_load_dwordx2 v[220:221], v63, s[8:9] offset:0 nt
    global_load_dwordx2 v[222:223], v63, s[8:9] offset:896 nt
    global_load_dwordx2 v[224:225], v63, s[8:9] offset:1792 nt
    global_load_dwordx2 v[226:227], v63, s[8:9] offset:2688 nt
    s_add_u32 s48, s36, 4194304
    s_addc_u32 s49, s37, 0
    s_and_b32 s49, s49, 0xffff
    s_mov_b32 s50, 0x1c0000
    s_mov_b32 s51, 0x20000
    s_lshl_b32 s55, s7, 18
    s_lshl_b32 s97, s6, 10
    s_add_u32 s55, s55, s97
    s_lshl_b32 s97, s4, 8
    s_add_u32 s55, s55, s97
    v_lshrrev_b32 v18, 4, v0
    v_lshlrev_b32 v18, 4, v18
    v_lshl_add_u32 v18, v16, 14, v18
    v_add_u32 v252, s55, v18
    s_lshl_b32 s63, s7, 8
    s_lshl_b32 s97, s6, 4
    s_add_u32 s63, s63, s97
    s_lshl_b32 s97, s4, 2
    s_add_u32 s63, s63, s97
    s_add_u32 s63, s63, 6295040
    v_mov_b32 v253, s63
    s_add_u32 s68, s36, 0
    s_addc_u32 s69, s37, 0
    s_and_b32 s69, s69, 0xffff
    s_mov_b32 s70, 0x1c0000
    s_mov_b32 s71, 0x20000
    s_lshl_b32 s55, s7, 18
    v_lshlrev_b32 v56, 14, v16
    v_lshl_add_u32 v56, v17, 4, v56
    v_add_u32 v56, s55, v56
    s_lshl_b32 s55, s7, 18
    s_lshl_b32 s97, s6, 14
    s_add_u32 s55, s55, s97
    s_lshl_b32 s97, s4, 12
    s_add_u32 s55, s55, s97
    v_lshl_add_u32 v57, v0, 4, s55
    v_lshl_add_u32 v254, v0, 6, s55
    s_movk_i32 s81, 4096
    s_movk_i32 s82, 8192
    s_movk_i32 s83, 12288
    s_lshl_b32 s55, s7, 8
    s_add_u32 s55, s55, 6291456
    v_lshl_add_u32 v60, v0, 2, s55
    s_lshl_b32 s64, s6, 4
    s_lshl_b32 s97, s4, 2
    s_add_u32 s64, s64, s97
    s_add_u32 s64, s64, s55
    v_mov_b32 v61, s64
    s_getreg_b32 s65, hwreg(HW_REG_XCC_ID, 0, 4)
    s_add_u32 s65, s65, 1
    s_mul_i32 s65, s65, 0x9e3779b9
    s_xor_b32 s65, s65, 0x6b8b4567
    v_mov_b32 v62, s65
    global_load_dword v255, v60, s[36:37] sc1
    v_and_b32 v15, 15, v0
    v_lshrrev_b32 v14, 4, v0
    v_and_b32 v13, 3, v15
    v_lshrrev_b32 v12, 2, v15
    v_mul_u32_u24 v16, 2368, v13
    v_lshl_add_u32 v16, v14, 4, v16
    v_lshlrev_b32 v17, 3, v12
    v_sub_u32 v16, v16, v17
    s_mul_i32 s55, s4, 9472
    s_add_u32 s55, s55, 24
    v_add_u32 v8, s55, v16
    v_lshlrev_b32 v16, 5, v15
    v_lshl_add_u32 v16, v14, 4, v16
    s_mul_i32 s55, s4, 4608
    s_add_u32 s55, s55, 109600
    v_add_u32 v9, s55, v16
    v_add_u32 v16, v14, v12
    v_and_b32 v16, 3, v16
    v_lshl_add_u32 v16, v13, 2, v16
    v_lshl_add_u32 v16, v12, 4, v16
    s_mul_i32 s55, s4, 4160
    s_add_u32 s55, s55, 136704
    v_lshl_add_u32 v10, v16, 3, s55
    s_lshl_b32 s55, s4, 2
    s_add_u32 s55, s55, 161280
    v_mov_b32 v11, s55
    s_mul_i32 s96, s4, 1088
    s_add_u32 s96, s96, 128000
    v_lshrrev_b32 v16, 5, v0
    v_lshlrev_b32 v16, 3, v16
    v_mov_b32 v211, s96
    v_lshl_add_u32 v197, v0, 4, s96
    v_and_b32 v17, 31, v0
    v_lshl_add_u32 v194, v17, 4, s96
    v_add_u32 v194, 8, v194
    v_add_u32 v195, v16, v194
    s_mul_i32 s96, s4, 9472
    s_add_u32 s96, s96, 1072
    v_lshlrev_b32 v16, 4, v0
    v_sub_u32 v198, s96, v16
    v_bfe_u32 v199, v0, 3, 2
    v_mul_u32_u24 v199, 2368, v199
    v_and_b32 v16, 7, v0
    v_lshl_add_u32 v199, v16, 2, v199
    s_mul_i32 s55, s4, 9472
    s_add_u32 s55, s55, 1088
    v_add_u32 v199, s55, v199
    s_branch L_A_PRO_J
L_A_PRO_H:
    s_mul_i32 s55, s6, 114688
    s_mul_i32 s97, s4, 28672
    s_add_u32 s55, s55, s97
    s_lshl_b32 s97, s7, 7
    s_add_u32 s55, s55, s97
    v_lshrrev_b32 v16, 1, v0
    v_mul_u32_u24 v16, 896, v16
    v_and_b32 v17, 1, v0
    v_lshl_add_u32 v16, v17, 6, v16
    v_add_u32 v16, s55, v16
    global_load_dword v63, v16, s[26:27] nt
    v_bfe_u32 v16, v0, 2, 2
    v_and_b32 v17, 3, v0
    v_lshrrev_b32 v18, 4, v0
    v_add_u32 v17, s4, v17
    v_and_b32 v17, 3, v17
    v_lshl_add_u32 v17, v18, 2, v17
    v_mul_u32_u24 v16, 4160, v16
    v_lshl_add_u32 v16, v17, 3, v16
    s_lshl_b32 s55, s4, 7
    s_add_u32 s55, s55, 136704
    v_add_u32 v8, s55, v16
    s_mov_b32 s40, s34
    s_and_b32 s41, s35, 0xffff
    s_mov_b32 s42, 0x380000
    s_mov_b32 s43, 0x20000
    s_mul_i32 s55, s4, 114688
    s_lshl_b32 s97, s5, 1
    s_add_u32 s55, s55, s97
    v_mul_u32_u24 v16, 1792, v0
    v_add_u32 v9, s55, v16
    s_mov_b32 s89, 458752
    s_mov_b32 s90, 917504
    s_mov_b32 s91, 1376256
    s_mov_b32 s92, 1835008
    s_mov_b32 s93, 2293760
    s_mov_b32 s94, 2752512
    s_mov_b32 s95, 3211264
    s_lshl_b32 s55, s4, 2
    s_add_u32 s55, s55, 161280
    v_mov_b32 v16, s55
    v_mov_b32 v17, 0
    ds_write_b32 v16, v17
    v_mov_b32 v6, 161280
    s_mul_i32 s96, s4, 1088
    s_add_u32 s96, s96, 132352
    v_mov_b32 v18, 0
    v_mov_b32 v19, 0
    v_mov_b32 v20, 0
    v_mov_b32 v21, 0
    v_lshl_add_u32 v196, v0, 4, s96
    ds_write_b128 v196, v[18:21]
    v_and_b32 v16, 15, v0
    v_lshl_add_u32 v16, v16, 2, s96
    ds_write_b32 v16, v18 offset:1024
    v_and_b32 v16, 1, v0
    v_bfe_u32 v17, v0, 1, 4
    v_cmp_gt_u32 vcc, 32, v0
    v_mul_u32_u24 v22, 144, v16
    v_mul_u32_u24 v23, 208, v16
    v_add_u32 v23, 576, v23
    v_cndmask_b32 v22, v22, v23, vcc
    v_lshl_add_u32 v22, v17, 1, v22
    v_add3_u32 v194, v22, s96, 40
    v_mov_b32 v22, 288
    v_mov_b32 v23, 64
    v_cndmask_b32 v22, v22, v23, vcc
    v_add_u32 v195, v22, v194
    v_lshrrev_b32 v16, 3, v0
    v_and_b32 v17, 7, v0
    v_mul_u32_u24 v22, 144, v16
    v_lshl_add_u32 v22, v17, 4, v22
    v_lshlrev_b32 v23, 7, v16
    v_lshlrev_b32 v17, 4, v17
    v_sub_u32 v23, v23, v17
    v_add_u32 v23, 1392, v23
    v_subrev_u32 v16, 32, v0
    v_lshlrev_b32 v17, 4, v16
    v_add_u32 v24, 576, v17
    v_sub_u32 v25, 1968, v17
    v_cndmask_b32 v22, v24, v22, vcc
    v_cndmask_b32 v23, v25, v23, vcc
    v_cmp_le_u32 vcc, 44, v0
    v_add_u32 v24, 16, v22
    v_add_u32 v25, 384, v23
    v_cndmask_b32 v22, v22, v24, vcc
    v_cndmask_b32 v23, v23, v25, vcc
    v_cmp_le_u32 vcc, 56, v0
    v_mov_b32 v24, 992
    v_mov_b32 v25, 48
    v_cndmask_b32 v22, v22, v24, vcc
    v_cndmask_b32 v23, v23, v25, vcc
    v_cmp_le_u32 vcc, 57, v0
    v_mov_b32 v24, 1024
    v_mov_b32 v25, 1184
    v_cndmask_b32 v22, v22, v24, vcc
    v_cndmask_b32 v23, v23, v25, vcc
    v_cmp_le_u32 vcc, 58, v0
    v_mov_b32 v24, 1040
    v_mov_b32 v25, 1168
    v_cndmask_b32 v22, v22, v24, vcc
    v_cndmask_b32 v23, v23, v25, vcc
    v_add_u32 v197, s96, v22
    s_mul_i32 s96, s4, 9472
    v_add_u32 v198, s96, v23
    v_lshrrev_b32 v16, 2, v0
    v_min_u32 v16, 10, v16
    v_lshlrev_b32 v17, 4, v16
    v_add_u32 v22, 1072, v17
    v_cmp_le_u32 vcc, 3, v16
    s_nop 1
    v_cndmask_b32 v17, v17, v22, vcc
    v_add_u32 v22, 32, v17
    v_cmp_le_u32 vcc, 6, v16
    s_nop 1
    v_cndmask_b32 v17, v17, v22, vcc
    v_and_b32 v16, 3, v0
    v_mul_u32_u24 v16, 2368, v16
    v_add3_u32 v199, v16, v17, s96
L_A_PRO_J:
    s_mul_i32 s55, s4, 4160
    s_lshl_b32 s97, s39, 11
    s_add_u32 s55, s55, s97
    s_add_u32 s55, s55, 136704
    v_lshl_add_u32 v193, v0, 4, s55
    s_xor_b32 s96, s39, 1
    s_mul_i32 s55, s4, 4160
    s_lshl_b32 s97, s96, 11
    s_add_u32 s55, s55, s97
    s_add_u32 s55, s55, 136704
    v_lshl_add_u32 v192, v0, 4, s55
    v_and_b32 v16, 31, v0
    v_lshrrev_b32 v17, 5, v0
    v_min_u32 v18, 20, v16
    v_mul_u32_u24 v18, 2064, v18
    v_mul_u32_u24 v19, 2064, v16
    s_lshl_b32 m0, s3, 8
    v_lshl_add_u32 v17, v17, 4, m0
    v_add_u32 v58, v18, v17
    v_add_u32 v19, v19, v17
    v_add_u32 v59, 43344, v19
    v_mov_b32 v16, 0x3f80
    ds_write_addtid_b32 v16 offset:43344
    s_mul_i32 s96, s4, 4608
    s_lshl_b32 s97, s39, 8
    s_add_u32 s96, s96, s97
    s_add_u32 s96, s96, 109568
    v_lshl_add_u32 v16, v0, 2, s96
    v_mov_b32 v17, 0
    ds_write_b32 v16, v17
    s_lshl_b32 s55, s4, 4
    s_waitcnt lgkmcnt(0)
    s_lshr_b64 s[72:73], s[72:73], s55
    s_lshr_b64 s[74:75], s[74:75], s55
    s_lshl_b32 s72, s72, 16
    s_lshl_b32 s62, s74, 16
    s_mov_b32 s55, 0x3fb8aa3b
    s_mov_b32 s96, 0x32a57060
    v_mov_b32 v16, s72
    v_mul_f32 v17, s55, v16
    v_fma_f32 v18, v16, s55, -v17
    v_exp_f32 v17, v17
    v_fma_f32 v18, v16, s96, v18
    v_mul_f32 v19, 0x3f317218, v17
    v_fma_f32 v17, v19, v18, v17
    v_cvt_pk_bf16_f32 v17, v17, v17
    v_and_b32 v17, 0xffff0000, v17
    v_mul_f32 v16, 0xbfb8aa3b, v17
    v_mul_f32 v18, 0.15915494, v17
    v_add_f32 v19, v17, v17
    v_readfirstlane_b32 s56, v16
    v_readfirstlane_b32 s57, v18
    v_readfirstlane_b32 s58, v19
    s_mov_b32 s60, 0x43800000
    s_mov_b32 s61, 0x43800000
    s_xor_b32 s59, s58, 0x80000000
    v_mov_b32 v210, s62
    v_cmp_eq_u32 vcc, 0, v0
    s_nop 1
    v_cndmask_b32 v210, 0, v210, vcc
    s_cmp_eq_u32 s39, 0
    s_cbranch_scc1 L_A_W_M
    s_waitcnt vmcnt(1)
    s_branch L_A_W_J
L_A_W_M:
    s_waitcnt vmcnt(9)
L_A_W_J:
    v_lshlrev_b32 v20, 16, v2
    v_lshlrev_b32 v21, 16, v3
    v_mul_f32 v20, 0x3fb8aa3b, v20
    v_lshlrev_b32 v24, 16, v4
    v_exp_f32 v20, v20
    v_lshlrev_b32 v25, 16, v5
    v_cvt_pk_bf16_f32 v20, v20, v20
    v_pk_mul_f32 v[26:27], v[24:25], s[58:59]
    v_and_b32 v20, 0xffff0000, v20
    v_cvt_pk_bf16_f32 v144, v26, v27
    v_pk_mul_f32 v[22:23], v[20:21], s[56:57]
    v_pk_mul_f32 v[54:55], v[22:23], s[60:61]
    v_fract_f32 v23, v23
    v_exp_f32 v16, v22
    v_cos_f32 v28, v23
    v_sin_f32 v29, v23
    v_exp_f32 v17, v54
    v_fract_f32 v55, v55
    ds_write_addtid_b32 v144 offset:0
    v_pk_mul_f32 v[28:29], v[28:29], v[16:17] op_sel_hi:[1,0]
    v_cos_f32 v38, v55
    v_pk_mul_f32 v[44:45], v[28:29], v[28:29] op_sel_hi:[1,0]
    v_sin_f32 v39, v55
    v_pk_fma_f32 v[30:31], v[28:29], v[28:29], v[44:45] op_sel:[1,1,0] op_sel_hi:[0,1,1] neg_lo:[0,1,0]
    v_pk_mul_f32 v[40:41], v[26:27], v[28:29] op_sel_hi:[1,0]
    v_pk_mul_f32 v[44:45], v[30:31], v[30:31] op_sel_hi:[1,0]
    v_pk_mul_f32 v[38:39], v[38:39], v[16:17] op_sel:[0,1]
    v_pk_fma_f32 v[32:33], v[30:31], v[30:31], v[44:45] op_sel:[1,1,0] op_sel_hi:[0,1,1] neg_lo:[0,1,0]
    v_pk_mul_f32 v[42:43], v[26:27], v[38:39] op_sel_hi:[1,0]
    v_pk_mul_f32 v[44:45], v[32:33], v[32:33] op_sel_hi:[1,0]
    v_pk_fma_f32 v[50:51], v[26:27], v[38:39], v[42:43] op_sel:[1,1,0] op_sel_hi:[0,1,1] neg_hi:[0,1,0]
    v_pk_fma_f32 v[34:35], v[32:33], v[32:33], v[44:45] op_sel:[1,1,0] op_sel_hi:[0,1,1] neg_lo:[0,1,0]
    v_pk_mul_f32 v[54:55], v[50:51], v[30:31] op_sel_hi:[1,0]
    v_pk_mul_f32 v[44:45], v[34:35], v[34:35] op_sel_hi:[1,0]
    v_pk_mul_f32 v[42:43], v[50:51], v[38:39] op_sel_hi:[1,0]
    v_pk_fma_f32 v[36:37], v[34:35], v[34:35], v[44:45] op_sel:[1,1,0] op_sel_hi:[0,1,1] neg_lo:[0,1,0]
    v_cvt_pk_bf16_f32 v145, v50, v51
    v_pk_fma_f32 v[52:53], v[50:51], v[30:31], v[54:55] op_sel:[1,1,0] op_sel_hi:[0,1,1] neg_hi:[0,1,0]
    v_pk_fma_f32 v[50:51], v[50:51], v[38:39], v[42:43] op_sel:[1,1,0] op_sel_hi:[0,1,1] neg_hi:[0,1,0]
    v_pk_mul_f32 v[44:45], v[36:37], v[34:35] op_sel_hi:[1,0]
    v_pk_fma_f32 v[26:27], v[26:27], v[28:29], v[40:41] op_sel:[1,1,0] op_sel_hi:[0,1,1] neg_hi:[0,1,0]
    v_pk_mul_f32 v[54:55], v[52:53], v[30:31] op_sel_hi:[1,0]
    v_pk_fma_f32 v[46:47], v[36:37], v[34:35], v[44:45] op_sel:[1,1,0] op_sel_hi:[0,1,1] neg_lo:[0,1,0]
    v_pk_mul_f32 v[42:43], v[50:51], v[32:33] op_sel_hi:[1,0]
    v_cvt_pk_bf16_f32 v146, v52, v53
    v_pk_mul_f32 v[40:41], v[26:27], v[28:29] op_sel_hi:[1,0]
    ds_write_addtid_b32 v145 offset:16512
    v_cvt_pk_bf16_f32 v148, v26, v27
    v_pk_fma_f32 v[52:53], v[52:53], v[30:31], v[54:55] op_sel:[1,1,0] op_sel_hi:[0,1,1] neg_hi:[0,1,0]
    v_pk_fma_f32 v[20:21], v[50:51], v[32:33], v[42:43] op_sel:[1,1,0] op_sel_hi:[0,1,1] neg_hi:[0,1,0]
    v_pk_mul_f32 v[44:45], v[46:47], v[34:35] op_sel_hi:[1,0]
    v_cvt_pk_bf16_f32 v149, v50, v51
    v_pk_fma_f32 v[26:27], v[26:27], v[28:29], v[40:41] op_sel:[1,1,0] op_sel_hi:[0,1,1] neg_hi:[0,1,0]
    v_cvt_pk_bf16_f32 v145, v46, v47
    v_pk_mul_f32 v[42:43], v[50:51], v[38:39] op_sel_hi:[1,0]
    v_pk_mul_f32 v[54:55], v[52:53], v[30:31] op_sel_hi:[1,0]
    v_pk_fma_f32 v[46:47], v[46:47], v[34:35], v[44:45] op_sel:[1,1,0] op_sel_hi:[0,1,1] neg_lo:[0,1,0]
    v_cvt_pk_bf16_f32 v147, v34, v35
    v_cvt_pk_bf16_f32 v150, v36, v37
    v_cvt_pk_bf16_f32 v151, v52, v53
    v_pk_mul_f32 v[40:41], v[26:27], v[28:29] op_sel_hi:[1,0]
    v_pk_fma_f32 v[50:51], v[50:51], v[38:39], v[42:43] op_sel:[1,1,0] op_sel_hi:[0,1,1] neg_hi:[0,1,0]
    ds_write_addtid_b32 v149 offset:24768
    v_cvt_pk_bf16_f32 v144, v26, v27
    v_pk_fma_f32 v[52:53], v[52:53], v[30:31], v[54:55] op_sel:[1,1,0] op_sel_hi:[0,1,1] neg_hi:[0,1,0]
    v_pk_mul_f32 v[44:45], v[46:47], v[34:35] op_sel_hi:[1,0]
    ds_write_addtid_b32 v146 offset:18576
    v_pk_fma_f32 v[26:27], v[26:27], v[28:29], v[40:41] op_sel:[1,1,0] op_sel_hi:[0,1,1] neg_hi:[0,1,0]
    v_cvt_pk_bf16_f32 v149, v46, v47
    v_pk_mul_f32 v[54:55], v[50:51], v[32:33] op_sel_hi:[1,0]
    ds_write_addtid_b32 v147 offset:45408
    ds_write_addtid_b32 v150 offset:47472
    v_cvt_pk_bf16_f32 v146, v20, v21
    v_pk_fma_f32 v[46:47], v[46:47], v[34:35], v[44:45] op_sel:[1,1,0] op_sel_hi:[0,1,1] neg_lo:[0,1,0]
    v_pk_mul_f32 v[42:43], v[50:51], v[38:39] op_sel_hi:[1,0]
    v_cvt_pk_bf16_f32 v147, v26, v27
    v_cvt_pk_bf16_f32 v150, v50, v51
    v_pk_fma_f32 v[20:21], v[50:51], v[32:33], v[54:55] op_sel:[1,1,0] op_sel_hi:[0,1,1] neg_hi:[0,1,0]
    ds_write_addtid_b32 v144 offset:4128
    v_pk_mul_f32 v[44:45], v[46:47], v[34:35] op_sel_hi:[1,0]
    v_pk_fma_f32 v[50:51], v[50:51], v[38:39], v[42:43] op_sel:[1,1,0] op_sel_hi:[0,1,1] neg_hi:[0,1,0]
    v_pk_mul_f32 v[40:41], v[26:27], v[28:29] op_sel_hi:[1,0]
    v_cvt_pk_bf16_f32 v144, v46, v47
    ds_write_addtid_b32 v147 offset:6192
    v_pk_fma_f32 v[46:47], v[46:47], v[34:35], v[44:45] op_sel:[1,1,0] op_sel_hi:[0,1,1] neg_lo:[0,1,0]
    v_pk_mul_f32 v[42:43], v[50:51], v[38:39] op_sel_hi:[1,0]
    v_pk_fma_f32 v[26:27], v[26:27], v[28:29], v[40:41] op_sel:[1,1,0] op_sel_hi:[0,1,1] neg_hi:[0,1,0]
    v_cvt_pk_bf16_f32 v147, v50, v51
    ds_write_addtid_b32 v146 offset:26832
    v_pk_fma_f32 v[50:51], v[50:51], v[38:39], v[42:43] op_sel:[1,1,0] op_sel_hi:[0,1,1] neg_hi:[0,1,0]
    v_pk_mul_f32 v[44:45], v[46:47], v[34:35] op_sel_hi:[1,0]
    ds_write_addtid_b32 v148 offset:2064
    ds_write_addtid_b32 v151 offset:20640
    v_cvt_pk_bf16_f32 v146, v46, v47
    v_pk_mul_f32 v[40:41], v[26:27], v[28:29] op_sel_hi:[1,0]
    v_cvt_pk_bf16_f32 v148, v52, v53
    ds_write_addtid_b32 v149 offset:51600
    v_cvt_pk_bf16_f32 v151, v26, v27
    v_pk_fma_f32 v[46:47], v[46:47], v[34:35], v[44:45] op_sel:[1,1,0] op_sel_hi:[0,1,1] neg_lo:[0,1,0]
    v_pk_mul_f32 v[42:43], v[50:51], v[38:39] op_sel_hi:[1,0]
    v_pk_fma_f32 v[26:27], v[26:27], v[28:29], v[40:41] op_sel:[1,1,0] op_sel_hi:[0,1,1] neg_hi:[0,1,0]
    v_cvt_pk_bf16_f32 v149, v50, v51
    ds_write_addtid_b32 v145 offset:49536
    ds_write_addtid_b32 v150 offset:28896
    v_pk_fma_f32 v[50:51], v[50:51], v[38:39], v[42:43] op_sel:[1,1,0] op_sel_hi:[0,1,1] neg_hi:[0,1,0]
    v_pk_mul_f32 v[44:45], v[46:47], v[34:35] op_sel_hi:[1,0]
    ds_write_addtid_b32 v148 offset:22704
    v_cvt_pk_bf16_f32 v145, v20, v21
    v_cvt_pk_bf16_f32 v150, v46, v47
    v_pk_mul_f32 v[40:41], v[26:27], v[28:29] op_sel_hi:[1,0]
    ds_write_addtid_b32 v144 offset:53664
    v_cvt_pk_bf16_f32 v148, v26, v27
    v_pk_fma_f32 v[46:47], v[46:47], v[34:35], v[44:45] op_sel:[1,1,0] op_sel_hi:[0,1,1] neg_lo:[0,1,0]
    v_pk_mul_f32 v[42:43], v[50:51], v[38:39] op_sel_hi:[1,0]
    v_pk_fma_f32 v[26:27], v[26:27], v[28:29], v[40:41] op_sel:[1,1,0] op_sel_hi:[0,1,1] neg_hi:[0,1,0]
    v_cvt_pk_bf16_f32 v144, v50, v51
    ds_write_addtid_b32 v145 offset:30960
    v_pk_fma_f32 v[50:51], v[50:51], v[38:39], v[42:43] op_sel:[1,1,0] op_sel_hi:[0,1,1] neg_hi:[0,1,0]
    v_pk_mul_f32 v[44:45], v[46:47], v[34:35] op_sel_hi:[1,0]
    ds_write_addtid_b32 v151 offset:8256
    v_cvt_pk_bf16_f32 v145, v46, v47
    v_pk_mul_f32 v[40:41], v[26:27], v[28:29] op_sel_hi:[1,0]
    ds_write_addtid_b32 v146 offset:55728
    v_cvt_pk_bf16_f32 v151, v26, v27
    v_pk_fma_f32 v[46:47], v[46:47], v[34:35], v[44:45] op_sel:[1,1,0] op_sel_hi:[0,1,1] neg_lo:[0,1,0]
    v_pk_mul_f32 v[42:43], v[50:51], v[38:39] op_sel_hi:[1,0]
    v_cvt_pk_bf16_f32 v146, v50, v51
    v_pk_fma_f32 v[26:27], v[26:27], v[28:29], v[40:41] op_sel:[1,1,0] op_sel_hi:[0,1,1] neg_hi:[0,1,0]
    v_pk_fma_f32 v[50:51], v[50:51], v[38:39], v[42:43] op_sel:[1,1,0] op_sel_hi:[0,1,1] neg_hi:[0,1,0]
    v_pk_mul_f32 v[40:41], v[46:47], v[34:35] op_sel_hi:[1,0]
    ds_write_addtid_b32 v148 offset:10320
    v_pk_mul_f32 v[42:43], v[46:47], v[36:37] op_sel_hi:[1,0]
    v_cvt_pk_bf16_f32 v148, v46, v47
    v_pk_fma_f32 v[48:49], v[46:47], v[34:35], v[40:41] op_sel:[1,1,0] op_sel_hi:[0,1,1] neg_lo:[0,1,0]
    v_pk_fma_f32 v[46:47], v[46:47], v[36:37], v[42:43] op_sel:[1,1,0] op_sel_hi:[0,1,1] neg_lo:[0,1,0]
    ds_write_addtid_b32 v150 offset:57792
    ds_write_addtid_b32 v151 offset:12384
    v_pk_mul_f32 v[40:41], v[48:49], v[36:37] op_sel_hi:[1,0]
    v_pk_mul_f32 v[42:43], v[46:47], v[36:37] op_sel_hi:[1,0]
    v_cvt_pk_bf16_f32 v150, v48, v49
    v_cvt_pk_bf16_f32 v151, v46, v47
    v_pk_fma_f32 v[48:49], v[48:49], v[36:37], v[40:41] op_sel:[1,1,0] op_sel_hi:[0,1,1] neg_lo:[0,1,0]
    v_pk_fma_f32 v[46:47], v[46:47], v[36:37], v[42:43] op_sel:[1,1,0] op_sel_hi:[0,1,1] neg_lo:[0,1,0]
    ds_write_addtid_b32 v147 offset:33024
    ds_write_addtid_b32 v144 offset:37152
    ds_write_addtid_b32 v145 offset:59856
    v_pk_mul_f32 v[40:41], v[48:49], v[36:37] op_sel_hi:[1,0]
    v_pk_mul_f32 v[42:43], v[46:47], v[36:37] op_sel_hi:[1,0]
    v_cvt_pk_bf16_f32 v147, v26, v27
    v_cvt_pk_bf16_f32 v144, v48, v49
    v_cvt_pk_bf16_f32 v145, v46, v47
    v_pk_fma_f32 v[48:49], v[48:49], v[36:37], v[40:41] op_sel:[1,1,0] op_sel_hi:[0,1,1] neg_lo:[0,1,0]
    v_pk_fma_f32 v[46:47], v[46:47], v[36:37], v[42:43] op_sel:[1,1,0] op_sel_hi:[0,1,1] neg_lo:[0,1,0]
    ds_write_addtid_b32 v149 offset:35088
    ds_write_addtid_b32 v146 offset:39216
    ds_write_addtid_b32 v147 offset:14448
    v_pk_mul_f32 v[40:41], v[48:49], v[36:37] op_sel_hi:[1,0]
    v_pk_mul_f32 v[42:43], v[46:47], v[36:37] op_sel_hi:[1,0]
    v_cvt_pk_bf16_f32 v149, v50, v51
    v_cvt_pk_bf16_f32 v146, v48, v49
    v_cvt_pk_bf16_f32 v147, v46, v47
    v_pk_fma_f32 v[48:49], v[48:49], v[36:37], v[40:41] op_sel:[1,1,0] op_sel_hi:[0,1,1] neg_lo:[0,1,0]
    v_pk_fma_f32 v[46:47], v[46:47], v[36:37], v[42:43] op_sel:[1,1,0] op_sel_hi:[0,1,1] neg_lo:[0,1,0]
    ds_write_addtid_b32 v148 offset:61920
    ds_write_addtid_b32 v149 offset:41280
    v_pk_mul_f32 v[40:41], v[48:49], v[36:37] op_sel_hi:[1,0]
    v_pk_mul_f32 v[42:43], v[46:47], v[36:37] op_sel_hi:[1,0]
    v_cvt_pk_bf16_f32 v148, v48, v49
    v_cvt_pk_bf16_f32 v149, v46, v47
    v_pk_fma_f32 v[48:49], v[48:49], v[36:37], v[40:41] op_sel:[1,1,0] op_sel_hi:[0,1,1] neg_lo:[0,1,0]
    v_pk_fma_f32 v[46:47], v[46:47], v[36:37], v[42:43] op_sel:[1,1,0] op_sel_hi:[0,1,1] neg_lo:[0,1,0]
    s_add_u32 m0, m0, 63488
    s_nop 0
    ds_write_addtid_b32 v150 offset:496
    ds_write_addtid_b32 v151 offset:2560
    v_pk_mul_f32 v[40:41], v[48:49], v[36:37] op_sel_hi:[1,0]
    v_pk_mul_f32 v[42:43], v[46:47], v[36:37] op_sel_hi:[1,0]
    v_cvt_pk_bf16_f32 v150, v48, v49
    v_cvt_pk_bf16_f32 v151, v46, v47
    v_pk_fma_f32 v[48:49], v[48:49], v[36:37], v[40:41] op_sel:[1,1,0] op_sel_hi:[0,1,1] neg_lo:[0,1,0]
    v_pk_fma_f32 v[46:47], v[46:47], v[36:37], v[42:43] op_sel:[1,1,0] op_sel_hi:[0,1,1] neg_lo:[0,1,0]
    ds_write_addtid_b32 v144 offset:4624
    ds_write_addtid_b32 v145 offset:6688
    v_pk_mul_f32 v[40:41], v[48:49], v[36:37] op_sel_hi:[1,0]
    v_pk_mul_f32 v[42:43], v[46:47], v[36:37] op_sel_hi:[1,0]
    v_cvt_pk_bf16_f32 v144, v48, v49
    v_cvt_pk_bf16_f32 v145, v46, v47
    v_pk_fma_f32 v[48:49], v[48:49], v[36:37], v[40:41] op_sel:[1,1,0] op_sel_hi:[0,1,1] neg_lo:[0,1,0]
    v_pk_fma_f32 v[46:47], v[46:47], v[36:37], v[42:43] op_sel:[1,1,0] op_sel_hi:[0,1,1] neg_lo:[0,1,0]
    ds_write_addtid_b32 v146 offset:8752
    ds_write_addtid_b32 v147 offset:10816
    v_pk_mul_f32 v[40:41], v[48:49], v[36:37] op_sel_hi:[1,0]
    v_pk_mul_f32 v[42:43], v[46:47], v[36:37] op_sel_hi:[1,0]
    v_cvt_pk_bf16_f32 v146, v48, v49
    v_cvt_pk_bf16_f32 v147, v46, v47
    v_pk_fma_f32 v[48:49], v[48:49], v[36:37], v[40:41] op_sel:[1,1,0] op_sel_hi:[0,1,1] neg_lo:[0,1,0]
    v_pk_fma_f32 v[46:47], v[46:47], v[36:37], v[42:43] op_sel:[1,1,0] op_sel_hi:[0,1,1] neg_lo:[0,1,0]
    ds_write_addtid_b32 v148 offset:12880
    ds_write_addtid_b32 v149 offset:14944
    v_pk_mul_f32 v[40:41], v[48:49], v[36:37] op_sel_hi:[1,0]
    v_pk_mul_f32 v[42:43], v[46:47], v[36:37] op_sel_hi:[1,0]
    v_cvt_pk_bf16_f32 v148, v48, v49
    v_cvt_pk_bf16_f32 v149, v46, v47
    v_pk_fma_f32 v[48:49], v[48:49], v[36:37], v[40:41] op_sel:[1,1,0] op_sel_hi:[0,1,1] neg_lo:[0,1,0]
    v_pk_fma_f32 v[46:47], v[46:47], v[36:37], v[42:43] op_sel:[1,1,0] op_sel_hi:[0,1,1] neg_lo:[0,1,0]
    ds_write_addtid_b32 v150 offset:17008
    ds_write_addtid_b32 v151 offset:19072
    v_pk_mul_f32 v[40:41], v[48:49], v[36:37] op_sel_hi:[1,0]
    v_pk_mul_f32 v[42:43], v[46:47], v[36:37] op_sel_hi:[1,0]
    v_cvt_pk_bf16_f32 v150, v48, v49
    v_cvt_pk_bf16_f32 v151, v46, v47
    v_pk_fma_f32 v[48:49], v[48:49], v[36:37], v[40:41] op_sel:[1,1,0] op_sel_hi:[0,1,1] neg_lo:[0,1,0]
    v_pk_fma_f32 v[46:47], v[46:47], v[36:37], v[42:43] op_sel:[1,1,0] op_sel_hi:[0,1,1] neg_lo:[0,1,0]
    ds_write_addtid_b32 v144 offset:21136
    ds_write_addtid_b32 v145 offset:23200
    v_pk_mul_f32 v[40:41], v[48:49], v[36:37] op_sel_hi:[1,0]
    v_pk_mul_f32 v[42:43], v[46:47], v[36:37] op_sel_hi:[1,0]
    v_cvt_pk_bf16_f32 v144, v48, v49
    v_cvt_pk_bf16_f32 v145, v46, v47
    v_pk_fma_f32 v[48:49], v[48:49], v[36:37], v[40:41] op_sel:[1,1,0] op_sel_hi:[0,1,1] neg_lo:[0,1,0]
    v_pk_fma_f32 v[46:47], v[46:47], v[36:37], v[42:43] op_sel:[1,1,0] op_sel_hi:[0,1,1] neg_lo:[0,1,0]
    ds_write_addtid_b32 v146 offset:25264
    ds_write_addtid_b32 v147 offset:27328
    v_cvt_pk_bf16_f32 v146, v48, v49
    v_cvt_pk_bf16_f32 v147, v46, v47
    ds_write_addtid_b32 v148 offset:29392
    ds_write_addtid_b32 v149 offset:31456
    ds_write_addtid_b32 v150 offset:33520
    ds_write_addtid_b32 v151 offset:35584
    ds_write_addtid_b32 v144 offset:37648
    ds_write_addtid_b32 v145 offset:39712
    ds_write_addtid_b32 v146 offset:41776
    ds_write_addtid_b32 v147 offset:43840
    s_cmp_eq_u32 s39, 0
    s_cbranch_scc0 L_A_MID
    s_waitcnt vmcnt(0)
    v_perm_b32 v228, v214, v212, s52
    v_perm_b32 v229, v218, v216, s52
    v_perm_b32 v230, v222, v220, s52
    v_perm_b32 v231, v226, v224, s52
    v_perm_b32 v232, v214, v212, s53
    v_perm_b32 v233, v218, v216, s53
    v_perm_b32 v234, v222, v220, s53
    v_perm_b32 v235, v226, v224, s53
    v_perm_b32 v236, v215, v213, s52
    v_perm_b32 v237, v219, v217, s52
    v_perm_b32 v238, v223, v221, s52
    v_perm_b32 v239, v227, v225, s52
    v_perm_b32 v240, v215, v213, s53
    v_perm_b32 v241, v219, v217, s53
    v_perm_b32 v242, v223, v221, s53
    v_perm_b32 v243, v227, v225, s53
    buffer_store_dwordx4 v[228:231], v56, s[68:71], 0 offen nt
    buffer_store_dwordx4 v[232:235], v56, s[68:71], s81 offen nt
    buffer_store_dwordx4 v[236:239], v56, s[68:71], s82 offen nt
    buffer_store_dwordx4 v[240:243], v56, s[68:71], s83 offen nt
    global_load_dwordx2 v[212:213], v63, s[22:23] offset:-3584 nt
    global_load_dwordx2 v[214:215], v63, s[22:23] offset:-2688 nt
    global_load_dwordx2 v[216:217], v63, s[22:23] offset:-1792 nt
    global_load_dwordx2 v[218:219], v63, s[22:23] offset:-896 nt
    global_load_dwordx2 v[220:221], v63, s[22:23] offset:0 nt
    global_load_dwordx2 v[222:223], v63, s[22:23] offset:896 nt
    global_load_dwordx2 v[224:225], v63, s[22:23] offset:1792 nt
    global_load_dwordx2 v[226:227], v63, s[22:23] offset:2688 nt
L_A_MID:
    s_nop 1
    s_lshl_b32 m0, s3, 8
    v_and_b32 v20, 0xffff0000, v2
    v_and_b32 v21, 0xffff0000, v3
    v_mul_f32 v20, 0x3fb8aa3b, v20
    ds_read_b128 v[64:67], v58 offset:0
    v_exp_f32 v20, v20
    ds_read_b128 v[96:99], v59 offset:0
    ds_read_b128 v[68:71], v58 offset:32
    v_cvt_pk_bf16_f32 v20, v20, v20
    ds_read_b128 v[100:103], v59 offset:32
    v_and_b32 v20, 0xffff0000, v20
    ds_read_b128 v[72:75], v58 offset:64
    v_pk_mul_f32 v[22:23], v[20:21], s[56:57]
    ds_read_b128 v[104:107], v59 offset:64
    v_pk_mul_f32 v[54:55], v[22:23], s[60:61]
    v_fract_f32 v23, v23
    v_exp_f32 v16, v22
    v_cos_f32 v28, v23
    v_sin_f32 v29, v23
    v_exp_f32 v17, v54
    ds_read_b128 v[76:79], v58 offset:96
    ds_read_b128 v[108:111], v59 offset:96
    v_pk_mul_f32 v[28:29], v[28:29], v[16:17] op_sel_hi:[1,0]
    ds_read_b128 v[80:83], v58 offset:128
    ds_read_b128 v[112:115], v59 offset:128
    v_pk_mul_f32 v[44:45], v[28:29], v[28:29] op_sel_hi:[1,0]
    ds_read_b128 v[84:87], v58 offset:160
    v_fract_f32 v55, v55
    ds_read_b128 v[116:119], v59 offset:160
    v_pk_fma_f32 v[30:31], v[28:29], v[28:29], v[44:45] op_sel:[1,1,0] op_sel_hi:[0,1,1] neg_lo:[0,1,0]
    ds_read_b128 v[88:91], v58 offset:192
    v_cos_f32 v38, v55
    v_sin_f32 v39, v55
    ds_read_b128 v[120:123], v59 offset:192
    v_and_b32 v24, 0xffff0000, v4
    v_and_b32 v25, 0xffff0000, v5
    v_pk_mul_f32 v[44:45], v[30:31], v[30:31] op_sel_hi:[1,0]
    ds_read_b128 v[92:95], v58 offset:224
    ds_read_b128 v[124:127], v59 offset:224
    v_pk_mul_f32 v[26:27], v[24:25], s[58:59]
    v_pk_mul_f32 v[38:39], v[38:39], v[16:17] op_sel:[0,1]
    v_pk_fma_f32 v[32:33], v[30:31], v[30:31], v[44:45] op_sel:[1,1,0] op_sel_hi:[0,1,1] neg_lo:[0,1,0]
    v_pk_mul_f32 v[42:43], v[26:27], v[38:39] op_sel_hi:[1,0]
    v_pk_mul_f32 v[44:45], v[32:33], v[32:33] op_sel_hi:[1,0]
    v_pk_fma_f32 v[152:153], v[26:27], v[38:39], v[42:43] op_sel:[1,1,0] op_sel_hi:[0,1,1] neg_hi:[0,1,0]
    v_pk_fma_f32 v[34:35], v[32:33], v[32:33], v[44:45] op_sel:[1,1,0] op_sel_hi:[0,1,1] neg_lo:[0,1,0]
    v_pk_mul_f32 v[40:41], v[26:27], v[28:29] op_sel_hi:[1,0]
    v_pk_mul_f32 v[54:55], v[152:153], v[30:31] op_sel_hi:[1,0]
    v_pk_mul_f32 v[44:45], v[34:35], v[34:35] op_sel_hi:[1,0]
    v_pk_fma_f32 v[154:155], v[26:27], v[28:29], v[40:41] op_sel:[1,1,0] op_sel_hi:[0,1,1] neg_hi:[0,1,0]
    v_pk_fma_f32 v[156:157], v[152:153], v[30:31], v[54:55] op_sel:[1,1,0] op_sel_hi:[0,1,1] neg_hi:[0,1,0]
    v_pk_fma_f32 v[36:37], v[34:35], v[34:35], v[44:45] op_sel:[1,1,0] op_sel_hi:[0,1,1] neg_lo:[0,1,0]
    s_waitcnt lgkmcnt(14)
    v_mfma_f32_32x32x16_bf16 v[128:143], v[64:67], v[96:99], 0
    v_cvt_pk_bf16_f32 v144, v26, v27
    v_cvt_pk_bf16_f32 v145, v152, v153
    v_cvt_pk_bf16_f32 v146, v34, v35
    ds_write_addtid_b32 v144 offset:0
    v_cvt_pk_bf16_f32 v147, v154, v155
    ds_write_addtid_b32 v145 offset:16512
    v_cvt_pk_bf16_f32 v148, v156, v157
    ds_write_addtid_b32 v146 offset:45408
    v_cvt_pk_bf16_f32 v149, v36, v37
    ds_write_addtid_b32 v147 offset:2064
    ds_write_addtid_b32 v148 offset:18576
    ds_write_addtid_b32 v149 offset:47472
    v_pk_mul_f32 v[42:43], v[152:153], v[38:39] op_sel_hi:[1,0]
    v_pk_mul_f32 v[40:41], v[154:155], v[28:29] op_sel_hi:[1,0]
    v_pk_mul_f32 v[44:45], v[36:37], v[34:35] op_sel_hi:[1,0]
    v_pk_fma_f32 v[158:159], v[152:153], v[38:39], v[42:43] op_sel:[1,1,0] op_sel_hi:[0,1,1] neg_hi:[0,1,0]
    v_pk_fma_f32 v[160:161], v[154:155], v[28:29], v[40:41] op_sel:[1,1,0] op_sel_hi:[0,1,1] neg_hi:[0,1,0]
    v_pk_fma_f32 v[164:165], v[36:37], v[34:35], v[44:45] op_sel:[1,1,0] op_sel_hi:[0,1,1] neg_lo:[0,1,0]
    v_pk_mul_f32 v[54:55], v[156:157], v[30:31] op_sel_hi:[1,0]
    v_pk_mul_f32 v[42:43], v[158:159], v[32:33] op_sel_hi:[1,0]
    v_pk_mul_f32 v[40:41], v[160:161], v[28:29] op_sel_hi:[1,0]
    v_pk_mul_f32 v[44:45], v[164:165], v[34:35] op_sel_hi:[1,0]
    v_pk_fma_f32 v[162:163], v[156:157], v[30:31], v[54:55] op_sel:[1,1,0] op_sel_hi:[0,1,1] neg_hi:[0,1,0]
    v_pk_fma_f32 v[166:167], v[158:159], v[32:33], v[42:43] op_sel:[1,1,0] op_sel_hi:[0,1,1] neg_hi:[0,1,0]
    v_pk_fma_f32 v[168:169], v[160:161], v[28:29], v[40:41] op_sel:[1,1,0] op_sel_hi:[0,1,1] neg_hi:[0,1,0]
    v_pk_fma_f32 v[170:171], v[164:165], v[34:35], v[44:45] op_sel:[1,1,0] op_sel_hi:[0,1,1] neg_lo:[0,1,0]
    s_waitcnt lgkmcnt(15)
    v_mfma_f32_32x32x16_bf16 v[128:143], v[68:71], v[100:103], v[128:143]
    v_cvt_pk_bf16_f32 v150, v158, v159
    v_cvt_pk_bf16_f32 v151, v160, v161
    v_cvt_pk_bf16_f32 v144, v162, v163
    ds_write_addtid_b32 v150 offset:24768
    v_cvt_pk_bf16_f32 v145, v164, v165
    ds_write_addtid_b32 v151 offset:4128
    v_cvt_pk_bf16_f32 v146, v166, v167
    ds_write_addtid_b32 v144 offset:20640
    v_cvt_pk_bf16_f32 v147, v168, v169
    ds_write_addtid_b32 v145 offset:49536
    v_cvt_pk_bf16_f32 v148, v170, v171
    ds_write_addtid_b32 v146 offset:26832
    ds_write_addtid_b32 v147 offset:6192
    ds_write_addtid_b32 v148 offset:51600
    v_pk_mul_f32 v[40:41], v[168:169], v[28:29] op_sel_hi:[1,0]
    v_pk_mul_f32 v[42:43], v[158:159], v[38:39] op_sel_hi:[1,0]
    v_pk_mul_f32 v[44:45], v[170:171], v[34:35] op_sel_hi:[1,0]
    v_pk_mul_f32 v[54:55], v[162:163], v[30:31] op_sel_hi:[1,0]
    v_pk_fma_f32 v[174:175], v[168:169], v[28:29], v[40:41] op_sel:[1,1,0] op_sel_hi:[0,1,1] neg_hi:[0,1,0]
    v_pk_fma_f32 v[176:177], v[158:159], v[38:39], v[42:43] op_sel:[1,1,0] op_sel_hi:[0,1,1] neg_hi:[0,1,0]
    v_pk_fma_f32 v[178:179], v[170:171], v[34:35], v[44:45] op_sel:[1,1,0] op_sel_hi:[0,1,1] neg_lo:[0,1,0]
    v_pk_fma_f32 v[172:173], v[162:163], v[30:31], v[54:55] op_sel:[1,1,0] op_sel_hi:[0,1,1] neg_hi:[0,1,0]
    v_pk_mul_f32 v[54:55], v[176:177], v[32:33] op_sel_hi:[1,0]
    v_pk_mul_f32 v[44:45], v[178:179], v[34:35] op_sel_hi:[1,0]
    v_pk_mul_f32 v[40:41], v[174:175], v[28:29] op_sel_hi:[1,0]
    v_pk_fma_f32 v[180:181], v[176:177], v[32:33], v[54:55] op_sel:[1,1,0] op_sel_hi:[0,1,1] neg_hi:[0,1,0]
    v_pk_fma_f32 v[182:183], v[178:179], v[34:35], v[44:45] op_sel:[1,1,0] op_sel_hi:[0,1,1] neg_lo:[0,1,0]
    v_pk_fma_f32 v[184:185], v[174:175], v[28:29], v[40:41] op_sel:[1,1,0] op_sel_hi:[0,1,1] neg_hi:[0,1,0]
    v_mfma_f32_32x32x16_bf16 v[128:143], v[72:75], v[104:107], v[128:143]
    v_cvt_pk_bf16_f32 v149, v172, v173
    v_cvt_pk_bf16_f32 v150, v174, v175
    v_cvt_pk_bf16_f32 v151, v176, v177
    ds_write_addtid_b32 v149 offset:22704
    v_cvt_pk_bf16_f32 v144, v178, v179
    ds_write_addtid_b32 v150 offset:8256
    v_cvt_pk_bf16_f32 v145, v180, v181
    ds_write_addtid_b32 v151 offset:28896
    v_cvt_pk_bf16_f32 v146, v182, v183
    ds_write_addtid_b32 v144 offset:53664
    v_cvt_pk_bf16_f32 v147, v184, v185
    ds_write_addtid_b32 v145 offset:30960
    ds_write_addtid_b32 v146 offset:55728
    ds_write_addtid_b32 v147 offset:10320
    s_cmp_eq_u32 s39, 0
    s_cbranch_scc0 L_A_NOFLAG
    s_waitcnt vmcnt(8)
    s_mov_b64 exec, 1
    global_store_dword v61, v62, s[36:37]
    s_mov_b64 exec, -1
L_A_NOFLAG:
    v_pk_mul_f32 v[42:43], v[176:177], v[38:39] op_sel_hi:[1,0]
    v_pk_mul_f32 v[44:45], v[182:183], v[34:35] op_sel_hi:[1,0]
    v_pk_fma_f32 v[186:187], v[176:177], v[38:39], v[42:43] op_sel:[1,1,0] op_sel_hi:[0,1,1] neg_hi:[0,1,0]
    v_pk_fma_f32 v[188:189], v[182:183], v[34:35], v[44:45] op_sel:[1,1,0] op_sel_hi:[0,1,1] neg_lo:[0,1,0]
    v_pk_mul_f32 v[42:43], v[186:187], v[38:39] op_sel_hi:[1,0]
    v_pk_mul_f32 v[40:41], v[184:185], v[28:29] op_sel_hi:[1,0]
    v_pk_fma_f32 v[190:191], v[186:187], v[38:39], v[42:43] op_sel:[1,1,0] op_sel_hi:[0,1,1] neg_hi:[0,1,0]
    v_pk_mul_f32 v[44:45], v[188:189], v[34:35] op_sel_hi:[1,0]
    v_pk_mul_f32 v[42:43], v[190:191], v[38:39] op_sel_hi:[1,0]
    v_pk_fma_f32 v[152:153], v[184:185], v[28:29], v[40:41] op_sel:[1,1,0] op_sel_hi:[0,1,1] neg_hi:[0,1,0]
    v_pk_fma_f32 v[154:155], v[190:191], v[38:39], v[42:43] op_sel:[1,1,0] op_sel_hi:[0,1,1] neg_hi:[0,1,0]
    v_pk_fma_f32 v[156:157], v[188:189], v[34:35], v[44:45] op_sel:[1,1,0] op_sel_hi:[0,1,1] neg_lo:[0,1,0]
    s_waitcnt lgkmcnt(15)
    v_mfma_f32_32x32x16_bf16 v[128:143], v[76:79], v[108:111], v[128:143]
    v_cvt_pk_bf16_f32 v148, v186, v187
    v_cvt_pk_bf16_f32 v149, v188, v189
    v_cvt_pk_bf16_f32 v150, v190, v191
    ds_write_addtid_b32 v148 offset:33024
    v_cvt_pk_bf16_f32 v151, v152, v153
    ds_write_addtid_b32 v149 offset:57792
    v_cvt_pk_bf16_f32 v144, v154, v155
    ds_write_addtid_b32 v150 offset:35088
    v_cvt_pk_bf16_f32 v145, v156, v157
    ds_write_addtid_b32 v151 offset:12384
    ds_write_addtid_b32 v144 offset:37152
    ds_write_addtid_b32 v145 offset:59856
    v_pk_mul_f32 v[42:43], v[154:155], v[38:39] op_sel_hi:[1,0]
    v_pk_mul_f32 v[44:45], v[156:157], v[34:35] op_sel_hi:[1,0]
    v_pk_fma_f32 v[158:159], v[154:155], v[38:39], v[42:43] op_sel:[1,1,0] op_sel_hi:[0,1,1] neg_hi:[0,1,0]
    v_pk_mul_f32 v[40:41], v[152:153], v[28:29] op_sel_hi:[1,0]
    v_pk_mul_f32 v[42:43], v[158:159], v[38:39] op_sel_hi:[1,0]
    v_pk_fma_f32 v[162:163], v[156:157], v[34:35], v[44:45] op_sel:[1,1,0] op_sel_hi:[0,1,1] neg_lo:[0,1,0]
    v_pk_fma_f32 v[160:161], v[152:153], v[28:29], v[40:41] op_sel:[1,1,0] op_sel_hi:[0,1,1] neg_hi:[0,1,0]
    v_pk_fma_f32 v[164:165], v[158:159], v[38:39], v[42:43] op_sel:[1,1,0] op_sel_hi:[0,1,1] neg_hi:[0,1,0]
    v_pk_mul_f32 v[40:41], v[162:163], v[34:35] op_sel_hi:[1,0]
    v_pk_mul_f32 v[42:43], v[162:163], v[36:37] op_sel_hi:[1,0]
    v_pk_fma_f32 v[166:167], v[162:163], v[34:35], v[40:41] op_sel:[1,1,0] op_sel_hi:[0,1,1] neg_lo:[0,1,0]
    v_pk_fma_f32 v[168:169], v[162:163], v[36:37], v[42:43] op_sel:[1,1,0] op_sel_hi:[0,1,1] neg_lo:[0,1,0]
    v_mfma_f32_32x32x16_bf16 v[128:143], v[80:83], v[112:115], v[128:143]
    v_cvt_pk_bf16_f32 v146, v158, v159
    v_cvt_pk_bf16_f32 v147, v160, v161
    v_cvt_pk_bf16_f32 v148, v162, v163
    ds_write_addtid_b32 v146 offset:39216
    v_cvt_pk_bf16_f32 v149, v164, v165
    ds_write_addtid_b32 v147 offset:14448
    v_cvt_pk_bf16_f32 v150, v166, v167
    ds_write_addtid_b32 v148 offset:61920
    v_cvt_pk_bf16_f32 v151, v168, v169
    ds_write_addtid_b32 v149 offset:41280
    s_add_u32 m0, m0, 63488
    s_nop 0
    ds_write_addtid_b32 v150 offset:496
    ds_write_addtid_b32 v151 offset:2560
    v_pk_mul_f32 v[40:41], v[166:167], v[36:37] op_sel_hi:[1,0]
    v_pk_mul_f32 v[42:43], v[168:169], v[36:37] op_sel_hi:[1,0]
    v_pk_fma_f32 v[170:171], v[166:167], v[36:37], v[40:41] op_sel:[1,1,0] op_sel_hi:[0,1,1] neg_lo:[0,1,0]
    v_pk_fma_f32 v[172:173], v[168:169], v[36:37], v[42:43] op_sel:[1,1,0] op_sel_hi:[0,1,1] neg_lo:[0,1,0]
    v_pk_mul_f32 v[40:41], v[170:171], v[36:37] op_sel_hi:[1,0]
    v_pk_mul_f32 v[42:43], v[172:173], v[36:37] op_sel_hi:[1,0]
    v_pk_fma_f32 v[174:175], v[170:171], v[36:37], v[40:41] op_sel:[1,1,0] op_sel_hi:[0,1,1] neg_lo:[0,1,0]
    v_pk_fma_f32 v[176:177], v[172:173], v[36:37], v[42:43] op_sel:[1,1,0] op_sel_hi:[0,1,1] neg_lo:[0,1,0]
    v_pk_mul_f32 v[40:41], v[174:175], v[36:37] op_sel_hi:[1,0]
    v_pk_mul_f32 v[42:43], v[176:177], v[36:37] op_sel_hi:[1,0]
    v_pk_fma_f32 v[178:179], v[174:175], v[36:37], v[40:41] op_sel:[1,1,0] op_sel_hi:[0,1,1] neg_lo:[0,1,0]
    v_pk_fma_f32 v[180:181], v[176:177], v[36:37], v[42:43] op_sel:[1,1,0] op_sel_hi:[0,1,1] neg_lo:[0,1,0]
    v_pk_mul_f32 v[40:41], v[178:179], v[36:37] op_sel_hi:[1,0]
    v_pk_fma_f32 v[182:183], v[178:179], v[36:37], v[40:41] op_sel:[1,1,0] op_sel_hi:[0,1,1] neg_lo:[0,1,0]
    v_mfma_f32_32x32x16_bf16 v[128:143], v[84:87], v[116:119], v[128:143]
    v_cvt_pk_bf16_f32 v144, v170, v171
    v_cvt_pk_bf16_f32 v145, v172, v173
    v_cvt_pk_bf16_f32 v146, v174, v175
    ds_write_addtid_b32 v144 offset:4624
    v_cvt_pk_bf16_f32 v147, v176, v177
    ds_write_addtid_b32 v145 offset:6688
    v_cvt_pk_bf16_f32 v148, v178, v179
    ds_write_addtid_b32 v146 offset:8752
    v_cvt_pk_bf16_f32 v149, v180, v181
    ds_write_addtid_b32 v147 offset:10816
    v_cvt_pk_bf16_f32 v150, v182, v183
    ds_write_addtid_b32 v148 offset:12880
    ds_write_addtid_b32 v149 offset:14944
    ds_write_addtid_b32 v150 offset:17008
    v_pk_mul_f32 v[42:43], v[180:181], v[36:37] op_sel_hi:[1,0]
    v_pk_mul_f32 v[40:41], v[182:183], v[36:37] op_sel_hi:[1,0]
    v_pk_fma_f32 v[184:185], v[180:181], v[36:37], v[42:43] op_sel:[1,1,0] op_sel_hi:[0,1,1] neg_lo:[0,1,0]
    v_pk_fma_f32 v[186:187], v[182:183], v[36:37], v[40:41] op_sel:[1,1,0] op_sel_hi:[0,1,1] neg_lo:[0,1,0]
    v_pk_mul_f32 v[42:43], v[184:185], v[36:37] op_sel_hi:[1,0]
    v_pk_mul_f32 v[40:41], v[186:187], v[36:37] op_sel_hi:[1,0]
    v_pk_fma_f32 v[188:189], v[184:185], v[36:37], v[42:43] op_sel:[1,1,0] op_sel_hi:[0,1,1] neg_lo:[0,1,0]
    v_pk_fma_f32 v[190:191], v[186:187], v[36:37], v[40:41] op_sel:[1,1,0] op_sel_hi:[0,1,1] neg_lo:[0,1,0]
    v_pk_mul_f32 v[42:43], v[188:189], v[36:37] op_sel_hi:[1,0]
    v_pk_mul_f32 v[40:41], v[190:191], v[36:37] op_sel_hi:[1,0]
    v_pk_fma_f32 v[152:153], v[188:189], v[36:37], v[42:43] op_sel:[1,1,0] op_sel_hi:[0,1,1] neg_lo:[0,1,0]
    v_pk_fma_f32 v[154:155], v[190:191], v[36:37], v[40:41] op_sel:[1,1,0] op_sel_hi:[0,1,1] neg_lo:[0,1,0]
    v_pk_mul_f32 v[42:43], v[152:153], v[36:37] op_sel_hi:[1,0]
    v_pk_fma_f32 v[156:157], v[152:153], v[36:37], v[42:43] op_sel:[1,1,0] op_sel_hi:[0,1,1] neg_lo:[0,1,0]
    v_mfma_f32_32x32x16_bf16 v[128:143], v[88:91], v[120:123], v[128:143]
    v_cvt_pk_bf16_f32 v151, v184, v185
    v_cvt_pk_bf16_f32 v144, v186, v187
    v_cvt_pk_bf16_f32 v145, v188, v189
    ds_write_addtid_b32 v151 offset:19072
    v_cvt_pk_bf16_f32 v146, v190, v191
    ds_write_addtid_b32 v144 offset:21136
    v_cvt_pk_bf16_f32 v147, v152, v153
    ds_write_addtid_b32 v145 offset:23200
    v_cvt_pk_bf16_f32 v148, v154, v155
    ds_write_addtid_b32 v146 offset:25264
    v_cvt_pk_bf16_f32 v149, v156, v157
    ds_write_addtid_b32 v147 offset:27328
    ds_write_addtid_b32 v148 offset:29392
    ds_write_addtid_b32 v149 offset:31456
    v_pk_mul_f32 v[40:41], v[154:155], v[36:37] op_sel_hi:[1,0]
    v_pk_mul_f32 v[42:43], v[156:157], v[36:37] op_sel_hi:[1,0]
    v_pk_fma_f32 v[158:159], v[154:155], v[36:37], v[40:41] op_sel:[1,1,0] op_sel_hi:[0,1,1] neg_lo:[0,1,0]
    v_pk_fma_f32 v[160:161], v[156:157], v[36:37], v[42:43] op_sel:[1,1,0] op_sel_hi:[0,1,1] neg_lo:[0,1,0]
    v_pk_mul_f32 v[40:41], v[158:159], v[36:37] op_sel_hi:[1,0]
    v_pk_mul_f32 v[42:43], v[160:161], v[36:37] op_sel_hi:[1,0]
    v_pk_fma_f32 v[162:163], v[158:159], v[36:37], v[40:41] op_sel:[1,1,0] op_sel_hi:[0,1,1] neg_lo:[0,1,0]
    v_pk_fma_f32 v[164:165], v[160:161], v[36:37], v[42:43] op_sel:[1,1,0] op_sel_hi:[0,1,1] neg_lo:[0,1,0]
    v_pk_mul_f32 v[40:41], v[162:163], v[36:37] op_sel_hi:[1,0]
    v_pk_mul_f32 v[42:43], v[164:165], v[36:37] op_sel_hi:[1,0]
    v_pk_fma_f32 v[166:167], v[162:163], v[36:37], v[40:41] op_sel:[1,1,0] op_sel_hi:[0,1,1] neg_lo:[0,1,0]
    v_pk_fma_f32 v[168:169], v[164:165], v[36:37], v[42:43] op_sel:[1,1,0] op_sel_hi:[0,1,1] neg_lo:[0,1,0]
    v_mfma_f32_32x32x16_bf16 v[128:143], v[92:95], v[124:127], v[128:143]
    v_cvt_pk_bf16_f32 v150, v158, v159
    v_cvt_pk_bf16_f32 v151, v160, v161
    v_cvt_pk_bf16_f32 v144, v162, v163
    ds_write_addtid_b32 v150 offset:33520
    v_cvt_pk_bf16_f32 v145, v164, v165
    ds_write_addtid_b32 v151 offset:35584
    v_cvt_pk_bf16_f32 v146, v166, v167
    ds_write_addtid_b32 v144 offset:37648
    s_cmp_eq_u32 s39, 0
    s_cbranch_scc0 L_A_NOQS
    s_waitcnt vmcnt(0)
    buffer_store_dwordx4 v[212:215], v252, s[48:51], 0 offen offset:0 nt
    buffer_store_dwordx4 v[216:219], v252, s[48:51], 0 offen offset:64 nt
    buffer_store_dwordx4 v[220:223], v252, s[48:51], 0 offen offset:128 nt
    buffer_store_dwordx4 v[224:227], v252, s[48:51], 0 offen offset:192 nt
L_A_NOQS:
    v_cvt_pk_bf16_f32 v147, v168, v169
    ds_write_addtid_b32 v145 offset:39712
    ds_write_addtid_b32 v146 offset:41776
    ds_write_addtid_b32 v147 offset:43840
    ds_read_b128 v[64:67], v58 offset:0
    ds_read_b128 v[96:99], v59 offset:0
    ds_read_b128 v[68:71], v58 offset:32
    ds_read_b128 v[100:103], v59 offset:32
    ds_read_b128 v[72:75], v58 offset:64
    ds_read_b128 v[104:107], v59 offset:64
    ds_read_b128 v[76:79], v58 offset:96
    ds_read_b128 v[108:111], v59 offset:96
    ds_read_b128 v[80:83], v58 offset:128
    ds_read_b128 v[112:115], v59 offset:128
    ds_read_b128 v[84:87], v58 offset:160
    ds_read_b128 v[116:119], v59 offset:160
    ds_read_b128 v[88:91], v58 offset:192
    ds_read_b128 v[120:123], v59 offset:192
    ds_read_b128 v[92:95], v58 offset:224
    ds_read_b128 v[124:127], v59 offset:224
    s_waitcnt lgkmcnt(14)
    v_mfma_f32_32x32x16_bf16 v[128:143], v[64:67], v[96:99], v[128:143]
    s_waitcnt lgkmcnt(12)
    v_mfma_f32_32x32x16_bf16 v[128:143], v[68:71], v[100:103], v[128:143]
    s_waitcnt lgkmcnt(10)
    v_mfma_f32_32x32x16_bf16 v[128:143], v[72:75], v[104:107], v[128:143]
    s_waitcnt lgkmcnt(8)
    v_mfma_f32_32x32x16_bf16 v[128:143], v[76:79], v[108:111], v[128:143]
    s_waitcnt lgkmcnt(6)
    v_mfma_f32_32x32x16_bf16 v[128:143], v[80:83], v[112:115], v[128:143]
    s_waitcnt lgkmcnt(4)
    v_mfma_f32_32x32x16_bf16 v[128:143], v[84:87], v[116:119], v[128:143]
    s_waitcnt lgkmcnt(2)
    v_mfma_f32_32x32x16_bf16 v[128:143], v[88:91], v[120:123], v[128:143]
    s_waitcnt lgkmcnt(0)
    v_mfma_f32_32x32x16_bf16 v[128:143], v[92:95], v[124:127], v[128:143]
    s_cmp_eq_u32 s39, 0
    s_cbranch_scc1 L_A_M2
    s_nop 9
    ds_write_b128 v192, v[128:131] offset:0
    ds_write_b128 v192, v[132:135] offset:1024
    v_mov_b32 v16, 0
    v_mov_b32 v17, 0
    v_mov_b32 v18, 0
    v_mov_b32 v19, 0
    s_mov_b32 s74, 0
    s_mov_b32 s75, -1
    s_waitcnt lgkmcnt(0)
    s_barrier
    ds_read_b128 v[64:67], v193
    ds_read_b128 v[68:71], v193 offset:1024
    ds_write_b128 v199, v[16:19]
    s_waitcnt lgkmcnt(2)
    v_add_f32 v132, v132, v64
    v_add_f32 v133, v133, v65
    v_add_f32 v134, v134, v66
    v_add_f32 v135, v135, v67
    s_waitcnt lgkmcnt(1)
    v_add_f32 v136, v136, v68
    v_add_f32 v137, v137, v69
    v_add_f32 v138, v138, v70
    v_add_f32 v139, v139, v71
    v_readlane_b32 s55, v132, 32
    v_readlane_b32 s96, v136, 0
    v_cndmask_b32 v80, v136, v132, s[74:75]
    v_cndmask_b32 v81, v137, v134, s[74:75]
    v_cndmask_b32 v82, v138, v133, s[74:75]
    v_cndmask_b32 v83, v139, v135, s[74:75]
    v_cvt_pk_bf16_f32 v84, v80, v81
    v_cvt_pk_bf16_f32 v85, v82, v83
    v_cvt_pk_bf16_f32 v86, v136, v136
    v_subrev_f32 v135, s55, v135
    s_xor_b32 s96, s96, 0x80000000
    v_cvt_pk_bf16_f32 v87, v134, v134
    v_mov_b32 v89, s96
    v_cvt_pk_bf16_f32 v88, v135, v135
    v_cvt_pk_bf16_f32 v89, v89, v89
    ds_write_b16 v194, v84
    ds_write_b16_d16_hi v194, v84 offset:32
    ds_write_b16 v195, v85
    ds_write_b16_d16_hi v195, v85 offset:32
    s_mov_b32 exec_lo, 0
    s_mov_b32 exec_hi, 1
    ds_write_b16 v194, v86 offset:704
    s_mov_b32 exec_lo, 0x80000000
    s_mov_b32 exec_hi, 0
    ds_write_b32 v194, v87 offset:138
    ds_write_b16 v194, v88 offset:142
    ds_write_b32 v194, v89 offset:186
    s_mov_b64 exec, -1
    ds_read_b128 v[64:67], v197
    ds_read_b64 v[68:69], v197 offset:16
    s_waitcnt lgkmcnt(0)
    v_bfi_b32 v160, s54, v68, v67
    v_bfi_b32 v161, s54, v67, v66
    v_bfi_b32 v162, s54, v66, v65
    v_bfi_b32 v163, s54, v65, v64
    ds_write_b128 v198, v[160:163] offset:0
    v_alignbit_b32 v164, v68, v68, 16
    v_alignbit_b32 v165, v67, v67, 16
    v_alignbit_b32 v166, v66, v66, 16
    v_alignbit_b32 v167, v65, v65, 16
    ds_write_b128 v198, v[164:167] offset:2368
    v_bfi_b32 v168, s54, v69, v68
    v_bfi_b32 v169, s54, v68, v67
    v_bfi_b32 v170, s54, v67, v66
    v_bfi_b32 v171, s54, v66, v65
    ds_write_b128 v198, v[168:171] offset:4736
    v_alignbit_b32 v172, v69, v69, 16
    v_alignbit_b32 v173, v68, v68, 16
    v_alignbit_b32 v174, v67, v67, 16
    v_alignbit_b32 v175, v66, v66, 16
    ds_write_b128 v198, v[172:175] offset:7104
    s_waitcnt lgkmcnt(0)
    s_barrier
    s_setprio 1
L_WT_0_0:
    ds_read_b128 v[12:15], v6
    s_waitcnt lgkmcnt(0)
    v_min_u32 v12, v12, v13
    v_min3_u32 v12, v12, v14, v15
    s_nop 0
    v_readfirstlane_b32 s55, v12
    s_nop 0
    s_cmp_ge_u32 s55, 1
    s_cbranch_scc1 L_WT_0_0_OK
    s_branch L_WT_0_0
L_WT_0_0_OK:
    ds_read_b64_tr_b16 v[16:17], v8 offset:0
    s_waitcnt lgkmcnt(0)
    buffer_store_dwordx2 v[16:17], v9, s[40:43], 0 offen
L_WT_0_1:
    ds_read_b128 v[12:15], v6
    s_waitcnt lgkmcnt(0)
    v_min_u32 v12, v12, v13
    v_min3_u32 v12, v12, v14, v15
    s_nop 0
    v_readfirstlane_b32 s55, v12
    s_nop 0
    s_cmp_ge_u32 s55, 2
    s_cbranch_scc1 L_WT_0_1_OK
    s_branch L_WT_0_1
L_WT_0_1_OK:
    ds_read_b64_tr_b16 v[18:19], v8 offset:512
    s_waitcnt lgkmcnt(0)
    buffer_store_dwordx2 v[18:19], v9, s[40:43], s89 offen
L_WT_0_2:
    ds_read_b128 v[12:15], v6
    s_waitcnt lgkmcnt(0)
    v_min_u32 v12, v12, v13
    v_min3_u32 v12, v12, v14, v15
    s_nop 0
    v_readfirstlane_b32 s55, v12
    s_nop 0
    s_cmp_ge_u32 s55, 3
    s_cbranch_scc1 L_WT_0_2_OK
    s_branch L_WT_0_2
L_WT_0_2_OK:
    ds_read_b64_tr_b16 v[20:21], v8 offset:1024
    s_waitcnt lgkmcnt(0)
    buffer_store_dwordx2 v[20:21], v9, s[40:43], s90 offen
L_WT_0_3:
    ds_read_b128 v[12:15], v6
    s_waitcnt lgkmcnt(0)
    v_min_u32 v12, v12, v13
    v_min3_u32 v12, v12, v14, v15
    s_nop 0
    v_readfirstlane_b32 s55, v12
    s_nop 0
    s_cmp_ge_u32 s55, 4
    s_cbranch_scc1 L_WT_0_3_OK
    s_branch L_WT_0_3
L_WT_0_3_OK:
    ds_read_b64_tr_b16 v[22:23], v8 offset:1536
    s_waitcnt lgkmcnt(0)
    buffer_store_dwordx2 v[22:23], v9, s[40:43], s91 offen
L_WT_0_4:
    ds_read_b128 v[12:15], v6
    s_waitcnt lgkmcnt(0)
    v_min_u32 v12, v12, v13
    v_min3_u32 v12, v12, v14, v15
    s_nop 0
    v_readfirstlane_b32 s55, v12
    s_nop 0
    s_cmp_ge_u32 s55, 5
    s_cbranch_scc1 L_WT_0_4_OK
    s_branch L_WT_0_4
L_WT_0_4_OK:
    ds_read_b64_tr_b16 v[24:25], v8 offset:2048
    s_waitcnt lgkmcnt(0)
    buffer_store_dwordx2 v[24:25], v9, s[40:43], s92 offen
L_WT_0_5:
    ds_read_b128 v[12:15], v6
    s_waitcnt lgkmcnt(0)
    v_min_u32 v12, v12, v13
    v_min3_u32 v12, v12, v14, v15
    s_nop 0
    v_readfirstlane_b32 s55, v12
    s_nop 0
    s_cmp_ge_u32 s55, 6
    s_cbranch_scc1 L_WT_0_5_OK
    s_branch L_WT_0_5
L_WT_0_5_OK:
    ds_read_b64_tr_b16 v[26:27], v8 offset:2560
    s_waitcnt lgkmcnt(0)
    buffer_store_dwordx2 v[26:27], v9, s[40:43], s93 offen
L_WT_0_6:
    ds_read_b128 v[12:15], v6
    s_waitcnt lgkmcnt(0)
    v_min_u32 v12, v12, v13
    v_min3_u32 v12, v12, v14, v15
    s_nop 0
    v_readfirstlane_b32 s55, v12
    s_nop 0
    s_cmp_ge_u32 s55, 7
    s_cbranch_scc1 L_WT_0_6_OK
    s_branch L_WT_0_6
L_WT_0_6_OK:
    ds_read_b64_tr_b16 v[28:29], v8 offset:3072
    s_waitcnt lgkmcnt(0)
    buffer_store_dwordx2 v[28:29], v9, s[40:43], s94 offen
    s_barrier
    ds_read_b64_tr_b16 v[30:31], v8 offset:3584
    s_waitcnt lgkmcnt(0)
    buffer_store_dwordx2 v[30:31], v9, s[40:43], s95 offen
    s_endpgm
L_A_M2:
    s_mul_i32 s55, s4, 4608
    s_add_u32 s55, s55, 110080
    s_mov_b32 m0, s55
    s_waitcnt vmcnt(0)
    s_mov_b64 exec, 1
    global_store_dword v253, v62, s[36:37]
    s_mov_b64 exec, -1
    s_movk_i32 s66, 64
L_A_POLL:
    s_sub_u32 s66, s66, 1
    s_cbranch_scc1 L_A_FAIL
    global_load_dword v16, v60, s[36:37] sc1
    s_waitcnt vmcnt(0)
    v_cmp_ne_u32 vcc, s65, v16
    s_nop 1
    s_cbranch_vccnz L_A_POLL
    buffer_load_dwordx4 v57, s[68:71], 0 offen offset:0 sc1 nt lds
    buffer_load_dwordx4 v57, s[68:71], 0 offen offset:1024 sc1 nt lds
    buffer_load_dwordx4 v57, s[68:71], 0 offen offset:2048 sc1 nt lds
    buffer_load_dwordx4 v57, s[68:71], 0 offen offset:3072 sc1 nt lds
L_A_GOT:
    s_getpc_b64 s[76:77]
L_PC2:
    s_add_u32 s76, s76, L_TAB-L_PC2
    s_addc_u32 s77, s77, 0
    v_lshlrev_b32 v16, 4, v0
    v_add_u32 v17, 3072, v16
    global_load_dwordx4 v[212:215], v16, s[76:77] offset:0
    global_load_dwordx4 v[216:219], v16, s[76:77] offset:1024
    global_load_dwordx4 v[220:223], v16, s[76:77] offset:2048
    global_load_dwordx4 v[224:227], v17, s[76:77] offset:0
    global_load_dwordx4 v[228:231], v17, s[76:77] offset:1024
    global_load_dwordx4 v[232:235], v17, s[76:77] offset:2048
    v_lshrrev_b32 v16, 4, v0
    v_lshlrev_b32 v16, 3, v16
    v_sub_u32 v4, v8, v16
    s_mul_i32 s55, s4, 4608
    s_add_u32 s55, s55, 109568
    v_subrev_u32 v16, 48, v9
    v_max_u32 v5, s55, v16
    ds_write_b128 v192, v[132:135] offset:0
    ds_write_b128 v192, v[136:139] offset:1024
    v_mov_b32 v18, 0
    v_mov_b32 v19, 0
    ds_write_b64 v211, v[18:19]
    ds_write_b16 v211, v18 offset:1030
    v_add_f32 v128, v128, v210
    s_waitcnt lgkmcnt(0)
    s_barrier
    ds_read_b128 v[68:71], v193 offset:1024
    ds_read_b128 v[64:67], v193
    ds_write_b32 v199, v18
    s_waitcnt lgkmcnt(2)
    v_add_f32 v132, v132, v68
    v_add_f32 v133, v133, v69
    v_add_f32 v134, v134, v70
    v_add_f32 v135, v135, v71
    v_readlane_b32 s55, v132, 32
    s_mov_b32 exec_lo, 0x80000000
    s_mov_b32 exec_hi, 0
    v_subrev_f32 v135, s55, v135
    s_mov_b64 exec, -1
    v_cvt_pk_bf16_f32 v88, v132, v132
    v_cvt_pk_bf16_f32 v89, v133, v134
    v_cvt_pk_bf16_f32 v90, v134, v134
    v_cvt_pk_bf16_f32 v91, v135, v135
    s_waitcnt lgkmcnt(1)
    v_add_f32 v128, v128, v64
    v_add_f32 v129, v129, v65
    v_add_f32 v130, v130, v66
    v_add_f32 v131, v131, v67
    v_cvt_pk_bf16_f32 v96, v128, v129
    v_cvt_pk_bf16_f32 v97, v130, v131
    s_mov_b32 exec_hi, 0
    ds_write_b16 v194, v88 offset:510
    ds_write_b64 v194, v[88:89] offset:512
    ds_write_b32 v194, v90 offset:520
    ds_write_b16 v194, v91 offset:524
    s_mov_b32 exec_hi, -1
    ds_write_b64 v195, v[96:97]
    ds_read_b128 v[64:67], v197
    ds_read_b64 v[68:69], v197 offset:16
    s_waitcnt lgkmcnt(0)
    v_bfi_b32 v160, s54, v68, v67
    v_bfi_b32 v161, s54, v67, v66
    v_bfi_b32 v162, s54, v66, v65
    v_bfi_b32 v163, s54, v65, v64
    ds_write_b128 v198, v[160:163] offset:0
    v_alignbit_b32 v164, v68, v68, 16
    v_alignbit_b32 v165, v67, v67, 16
    v_alignbit_b32 v166, v66, v66, 16
    v_alignbit_b32 v167, v65, v65, 16
    ds_write_b128 v198, v[164:167] offset:2368
    v_bfi_b32 v168, s54, v69, v68
    v_bfi_b32 v169, s54, v68, v67
    v_bfi_b32 v170, s54, v67, v66
    v_bfi_b32 v171, s54, v66, v65
    ds_write_b128 v198, v[168:171] offset:4736
    v_alignbit_b32 v172, v69, v69, 16
    v_alignbit_b32 v173, v68, v68, 16
    v_alignbit_b32 v174, v67, v67, 16
    v_alignbit_b32 v175, v66, v66, 16
    ds_write_b128 v198, v[172:175] offset:7104
    ds_read_b64 v[64:65], v8 offset:1024
    ds_read_b64 v[66:67], v8 offset:1032
    ds_read_b64 v[96:97], v8 offset:512
    ds_read_b64 v[98:99], v8 offset:520
    ds_read_b64 v[68:69], v8 offset:960
    ds_read_b64 v[70:71], v8 offset:968
    ds_read_b64 v[100:101], v8 offset:448
    ds_read_b64 v[102:103], v8 offset:456
    ds_read_b64 v[72:73], v8 offset:896
    ds_read_b64 v[74:75], v8 offset:904
    ds_read_b64 v[104:105], v8 offset:384
    ds_read_b64 v[106:107], v8 offset:392
    ds_read_b64 v[76:77], v8 offset:832
    ds_read_b64 v[78:79], v8 offset:840
    ds_read_b64 v[108:109], v8 offset:320
    ds_read_b64 v[110:111], v8 offset:328
    ds_read_b64 v[80:81], v8 offset:768
    ds_read_b64 v[82:83], v8 offset:776
    ds_read_b64 v[112:113], v8 offset:256
    ds_read_b64 v[114:115], v8 offset:264
    ds_read_b64 v[84:85], v8 offset:704
    ds_read_b64 v[86:87], v8 offset:712
    ds_read_b64 v[116:117], v8 offset:192
    ds_read_b64 v[118:119], v8 offset:200
    ds_read_b64 v[88:89], v8 offset:640
    ds_read_b64 v[90:91], v8 offset:648
    ds_read_b64 v[120:121], v8 offset:128
    ds_read_b64 v[122:123], v8 offset:136
    ds_read_b64 v[92:93], v8 offset:576
    ds_read_b64 v[94:95], v8 offset:584
    ds_read_b64 v[124:125], v8 offset:64
    ds_read_b64 v[126:127], v8 offset:72
    s_waitcnt vmcnt(0)
    ds_read_b128 v[16:19], v9 offset:448
    ds_read_b128 v[20:23], v9 offset:384
    ds_read_b128 v[24:27], v9 offset:320
    ds_read_b128 v[28:31], v9 offset:256
    ds_read_b128 v[32:35], v9 offset:192
    ds_read_b128 v[36:39], v9 offset:128
    ds_read_b128 v[248:251], v9 offset:64
    s_waitcnt lgkmcnt(6)
    v_mfma_f32_16x16x32_bf16 v[40:43], v[64:67], v[16:19], 0
    ds_read_b128 v[252:255], v9 offset:0
    v_mfma_f32_16x16x32_bf16 v[44:47], v[96:99], v[16:19], 0
    s_waitcnt lgkmcnt(6)
    v_mfma_f32_16x16x32_bf16 v[40:43], v[68:71], v[20:23], v[40:43]
    ds_read_b128 v[16:19], v5
    v_mfma_f32_16x16x32_bf16 v[44:47], v[100:103], v[20:23], v[44:47]
    ds_read_b128 v[20:23], v9 offset:960
    s_waitcnt lgkmcnt(7)
    v_mfma_f32_16x16x32_bf16 v[40:43], v[72:75], v[24:27], v[40:43]
    v_mfma_f32_16x16x32_bf16 v[44:47], v[104:107], v[24:27], v[44:47]
    ds_read_b128 v[24:27], v9 offset:896
    s_waitcnt lgkmcnt(7)
    v_mfma_f32_16x16x32_bf16 v[40:43], v[76:79], v[28:31], v[40:43]
    v_mfma_f32_16x16x32_bf16 v[44:47], v[108:111], v[28:31], v[44:47]
    ds_read_b128 v[28:31], v9 offset:832
    s_waitcnt lgkmcnt(7)
    v_mfma_f32_16x16x32_bf16 v[40:43], v[80:83], v[32:35], v[40:43]
    v_mfma_f32_16x16x32_bf16 v[44:47], v[112:115], v[32:35], v[44:47]
    ds_read_b128 v[32:35], v9 offset:768
    s_waitcnt lgkmcnt(7)
    v_mfma_f32_16x16x32_bf16 v[40:43], v[84:87], v[36:39], v[40:43]
    v_mfma_f32_16x16x32_bf16 v[44:47], v[116:119], v[36:39], v[44:47]
    ds_read_b128 v[36:39], v9 offset:704
    s_waitcnt lgkmcnt(7)
    v_mfma_f32_16x16x32_bf16 v[40:43], v[88:91], v[248:251], v[40:43]
    v_mfma_f32_16x16x32_bf16 v[44:47], v[120:123], v[248:251], v[44:47]
    ds_read_b128 v[248:251], v9 offset:640
    s_waitcnt lgkmcnt(7)
    v_mfma_f32_16x16x32_bf16 v[40:43], v[92:95], v[252:255], v[40:43]
    v_mfma_f32_16x16x32_bf16 v[44:47], v[124:127], v[252:255], v[44:47]
    ds_read_b128 v[252:255], v9 offset:576
    s_waitcnt lgkmcnt(7)
    v_mfma_f32_16x16x32_bf16 v[184:187], v[16:19], v[212:215], 0
    s_waitcnt lgkmcnt(6)
    v_mfma_f32_16x16x32_bf16 v[44:47], v[64:67], v[20:23], v[44:47]
    v_mov_b32 v238, 0
    v_mov_b32 v239, 0
    ds_read_b128 v[16:19], v9 offset:512
    v_mfma_f32_16x16x32_bf16 v[48:51], v[96:99], v[20:23], 0
    s_waitcnt lgkmcnt(6)
    v_mfma_f32_16x16x32_bf16 v[44:47], v[68:71], v[24:27], v[44:47]
    v_mfma_f32_16x16x32_bf16 v[48:51], v[100:103], v[24:27], v[48:51]
    s_barrier
    ds_read_b64 v[140:141], v4 offset:1344
    s_waitcnt lgkmcnt(6)
    v_mfma_f32_16x16x32_bf16 v[44:47], v[72:75], v[28:31], v[44:47]
    ds_read_b64 v[142:143], v4 offset:1728
    v_mfma_f32_16x16x32_bf16 v[48:51], v[104:107], v[28:31], v[48:51]
    ds_read_b128 v[20:23], v9 offset:448
    s_waitcnt lgkmcnt(7)
    v_mfma_f32_16x16x32_bf16 v[44:47], v[76:79], v[32:35], v[44:47]
    v_cvt_pk_bf16_f32 v12, v40, v41
    v_cvt_pk_bf16_f32 v13, v42, v43
    v_mov_b32 v7, 1
    ds_write_b64 v10, v[12:13] offset:0
    ds_write_b32 v11, v7
    v_mfma_f32_16x16x32_bf16 v[48:51], v[108:111], v[32:35], v[48:51]
    ds_read_b64 v[144:145], v4 offset:1312
    s_waitcnt lgkmcnt(9)
    v_mfma_f32_16x16x32_bf16 v[44:47], v[80:83], v[36:39], v[44:47]
    v_cvt_pk_bf16_f32 v236, v184, v185
    v_mfma_f32_16x16x32_bf16 v[48:51], v[112:115], v[36:39], v[48:51]
    v_cvt_pk_bf16_f32 v237, v186, v187
    ds_read_b128 v[24:27], v9 offset:464
    ds_read_b64 v[146:147], v4 offset:1696
    s_waitcnt lgkmcnt(10)
    v_mfma_f32_16x16x32_bf16 v[44:47], v[84:87], v[248:251], v[44:47]
    ds_read_b128 v[28:31], v9 offset:1472
    ds_read_b64 v[148:149], v4 offset:1280
    ds_read_b64 v[150:151], v4 offset:1664
    v_mfma_f32_16x16x32_bf16 v[48:51], v[116:119], v[248:251], v[48:51]
    ds_read_b64 v[128:129], v8 offset:0
    s_waitcnt lgkmcnt(13)
    v_mfma_f32_16x16x32_bf16 v[44:47], v[88:91], v[252:255], v[44:47]
    ds_read_b128 v[32:35], v9 offset:1408
    v_mfma_f32_16x16x32_bf16 v[48:51], v[120:123], v[252:255], v[48:51]
    ds_read_b64 v[130:131], v8 offset:8
    s_waitcnt lgkmcnt(14)
    v_mfma_f32_16x16x32_bf16 v[44:47], v[92:95], v[16:19], v[44:47]
    ds_read_b128 v[36:39], v9 offset:1344
    v_mfma_f32_16x16x32_bf16 v[48:51], v[124:127], v[16:19], v[48:51]
    ds_read_b64 v[152:153], v4 offset:1472
    s_waitcnt lgkmcnt(14)
    v_mfma_f32_16x16x32_bf16 v[44:47], v[236:239], v[140:143], v[44:47]
    ds_read_b128 v[248:251], v9 offset:1280
    s_waitcnt lgkmcnt(9)
    v_mfma_f32_16x16x32_bf16 v[48:51], v[236:239], v[144:147], v[48:51]
    ds_read_b64 v[154:155], v4 offset:1600
    s_waitcnt lgkmcnt(7)
    v_mfma_f32_16x16x32_bf16 v[52:55], v[236:239], v[148:151], 0
    ds_read_b128 v[252:255], v9 offset:1216
    v_mfma_f32_16x16x32_bf16 v[184:187], v[20:23], v[224:227], 0
    ds_read_b64 v[156:157], v4 offset:1440
    v_mfma_f32_16x16x32_bf16 v[188:191], v[20:23], v[216:219], 0
    ds_read_b128 v[16:19], v9 offset:1152
    v_mfma_f32_16x16x32_bf16 v[192:195], v[20:23], v[220:223], 0
    ds_read_b64 v[158:159], v4 offset:1568
    s_waitcnt lgkmcnt(8)
    v_mfma_f32_16x16x32_bf16 v[48:51], v[128:131], v[20:23], v[48:51]
    ds_read_b128 v[20:23], v9 offset:1088
    v_mfma_f32_16x16x32_bf16 v[196:199], v[24:27], v[212:215], 0
    ds_read_b64 v[160:161], v4 offset:1408
    v_mfma_f32_16x16x32_bf16 v[48:51], v[64:67], v[28:31], v[48:51]
    ds_read_b128 v[24:27], v9 offset:1024
    v_mfma_f32_16x16x32_bf16 v[52:55], v[96:99], v[28:31], v[52:55]
    v_cvt_pk_bf16_f32 v14, v44, v45
    v_cvt_pk_bf16_f32 v15, v46, v47
    v_mov_b32 v7, 2
    ds_write_b64 v10, v[14:15] offset:512
    ds_write_b32 v11, v7
    v_mfma_f32_16x16x32_bf16 v[48:51], v[68:71], v[32:35], v[48:51]
    ds_read_b64 v[162:163], v4 offset:1536
    v_mfma_f32_16x16x32_bf16 v[52:55], v[100:103], v[32:35], v[52:55]
    ds_read_b64 v[132:133], v8 offset:1184
    s_waitcnt lgkmcnt(14)
    v_mfma_f32_16x16x32_bf16 v[48:51], v[72:75], v[36:39], v[48:51]
    v_cvt_pk_bf16_f32 v238, v184, v185
    v_mfma_f32_16x16x32_bf16 v[52:55], v[104:107], v[36:39], v[52:55]
    v_cvt_pk_bf16_f32 v239, v186, v187
    s_waitcnt lgkmcnt(12)
    v_mfma_f32_16x16x32_bf16 v[48:51], v[76:79], v[248:251], v[48:51]
    v_cvt_pk_bf16_f32 v240, v188, v189
    v_mfma_f32_16x16x32_bf16 v[52:55], v[108:111], v[248:251], v[52:55]
    v_cvt_pk_bf16_f32 v241, v190, v191
    s_waitcnt lgkmcnt(10)
    v_mfma_f32_16x16x32_bf16 v[48:51], v[80:83], v[252:255], v[48:51]
    v_cvt_pk_bf16_f32 v242, v192, v193
    ds_read_b128 v[28:31], v9 offset:960
    v_mfma_f32_16x16x32_bf16 v[52:55], v[112:115], v[252:255], v[52:55]
    v_cvt_pk_bf16_f32 v243, v194, v195
    s_waitcnt lgkmcnt(9)
    v_mfma_f32_16x16x32_bf16 v[48:51], v[84:87], v[16:19], v[48:51]
    v_cvt_pk_bf16_f32 v236, v196, v197
    v_mfma_f32_16x16x32_bf16 v[52:55], v[116:119], v[16:19], v[52:55]
    v_cvt_pk_bf16_f32 v237, v198, v199
    s_waitcnt lgkmcnt(7)
    v_mfma_f32_16x16x32_bf16 v[48:51], v[88:91], v[20:23], v[48:51]
    ds_read_b128 v[32:35], v9 offset:976
    v_mfma_f32_16x16x32_bf16 v[52:55], v[120:123], v[20:23], v[52:55]
    ds_read_b128 v[36:39], v5
    s_waitcnt lgkmcnt(7)
    v_mfma_f32_16x16x32_bf16 v[48:51], v[92:95], v[24:27], v[48:51]
    ds_read_b128 v[248:251], v9 offset:0
    v_mfma_f32_16x16x32_bf16 v[52:55], v[124:127], v[24:27], v[52:55]
    ds_read_b128 v[252:255], v9 offset:1984
    v_mfma_f32_16x16x32_bf16 v[48:51], v[236:239], v[140:143], v[48:51]
    ds_read_b64 v[134:135], v8 offset:1192
    v_mfma_f32_16x16x32_bf16 v[48:51], v[240:243], v[152:155], v[48:51]
    ds_read_b128 v[16:19], v9 offset:1920
    v_mfma_f32_16x16x32_bf16 v[52:55], v[236:239], v[144:147], v[52:55]
    ds_read_b64 v[164:165], v4 offset:1920
    v_mfma_f32_16x16x32_bf16 v[52:55], v[240:243], v[156:159], v[52:55]
    ds_read_b128 v[20:23], v9 offset:1856
    v_mfma_f32_16x16x32_bf16 v[56:59], v[236:239], v[148:151], 0
    ds_read_b64 v[166:167], v4 offset:2112
    s_waitcnt lgkmcnt(11)
    v_mfma_f32_16x16x32_bf16 v[56:59], v[240:243], v[160:163], v[56:59]
    ds_read_b128 v[24:27], v9 offset:1792
    s_waitcnt lgkmcnt(10)
    v_mfma_f32_16x16x32_bf16 v[184:187], v[28:31], v[224:227], 0
    ds_read_b64 v[168:169], v4 offset:1888
    v_mfma_f32_16x16x32_bf16 v[188:191], v[28:31], v[216:219], 0
    ds_read_b64 v[170:171], v4 offset:2080
    v_mfma_f32_16x16x32_bf16 v[192:195], v[28:31], v[220:223], 0
    ds_read_b64 v[172:173], v4 offset:1856
    v_mfma_f32_16x16x32_bf16 v[52:55], v[128:131], v[28:31], v[52:55]
    ds_read_b128 v[28:31], v9 offset:1728
    s_waitcnt lgkmcnt(13)
    v_mfma_f32_16x16x32_bf16 v[196:199], v[32:35], v[212:215], 0
    ds_read_b128 v[32:35], v9 offset:1664
    v_cvt_pk_bf16_f32 v12, v48, v49
    v_cvt_pk_bf16_f32 v13, v50, v51
    v_mov_b32 v7, 3
    ds_write_b64 v10, v[12:13] offset:1024
    ds_write_b32 v11, v7
    s_waitcnt lgkmcnt(15)
    v_mfma_f32_16x16x32_bf16 v[200:203], v[36:39], v[228:231], 0
    ds_read_b128 v[36:39], v9 offset:1600
    s_waitcnt lgkmcnt(13)
    v_mfma_f32_16x16x32_bf16 v[52:55], v[132:135], v[248:251], v[52:55]
    ds_read_b64 v[174:175], v4 offset:2048
    v_mfma_f32_16x16x32_bf16 v[52:55], v[64:67], v[252:255], v[52:55]
    v_mov_b32 v246, 0
    v_mov_b32 v247, 0
    ds_read_b128 v[248:251], v9 offset:1536
    v_mfma_f32_16x16x32_bf16 v[56:59], v[96:99], v[252:255], v[56:59]
    ds_read_b64 v[176:177], v4 offset:1824
    s_waitcnt lgkmcnt(15)
    v_mfma_f32_16x16x32_bf16 v[52:55], v[68:71], v[16:19], v[52:55]
    v_cvt_pk_bf16_f32 v238, v184, v185
    v_mfma_f32_16x16x32_bf16 v[56:59], v[100:103], v[16:19], v[56:59]
    v_cvt_pk_bf16_f32 v239, v186, v187
    s_waitcnt lgkmcnt(13)
    v_mfma_f32_16x16x32_bf16 v[52:55], v[72:75], v[20:23], v[52:55]
    v_cvt_pk_bf16_f32 v240, v188, v189
    v_mfma_f32_16x16x32_bf16 v[56:59], v[104:107], v[20:23], v[56:59]
    v_cvt_pk_bf16_f32 v241, v190, v191
    s_waitcnt lgkmcnt(11)
    v_mfma_f32_16x16x32_bf16 v[52:55], v[76:79], v[24:27], v[52:55]
    v_cvt_pk_bf16_f32 v242, v192, v193
    v_mfma_f32_16x16x32_bf16 v[56:59], v[108:111], v[24:27], v[56:59]
    v_cvt_pk_bf16_f32 v243, v194, v195
    s_waitcnt lgkmcnt(7)
    v_mfma_f32_16x16x32_bf16 v[52:55], v[80:83], v[28:31], v[52:55]
    v_cvt_pk_bf16_f32 v236, v196, v197
    v_mfma_f32_16x16x32_bf16 v[56:59], v[112:115], v[28:31], v[56:59]
    v_cvt_pk_bf16_f32 v237, v198, v199
    s_waitcnt lgkmcnt(6)
    v_mfma_f32_16x16x32_bf16 v[52:55], v[84:87], v[32:35], v[52:55]
    v_cvt_pk_bf16_f32 v244, v200, v201
    v_mfma_f32_16x16x32_bf16 v[56:59], v[116:119], v[32:35], v[56:59]
    v_cvt_pk_bf16_f32 v245, v202, v203
    s_waitcnt lgkmcnt(3)
    v_mfma_f32_16x16x32_bf16 v[52:55], v[88:91], v[36:39], v[52:55]
    ds_read_b64 v[178:179], v4 offset:2016
    v_mfma_f32_16x16x32_bf16 v[56:59], v[120:123], v[36:39], v[56:59]
    ds_read_b128 v[252:255], v9 offset:1472
    s_waitcnt lgkmcnt(3)
    v_mfma_f32_16x16x32_bf16 v[52:55], v[92:95], v[248:251], v[52:55]
    ds_read_b64 v[180:181], v4 offset:1792
    v_mfma_f32_16x16x32_bf16 v[56:59], v[124:127], v[248:251], v[56:59]
    ds_read_b64 v[182:183], v4 offset:1984
    v_mfma_f32_16x16x32_bf16 v[52:55], v[236:239], v[140:143], v[52:55]
    ds_read_b64 v[136:137], v8 offset:1120
    v_mfma_f32_16x16x32_bf16 v[52:55], v[240:243], v[152:155], v[52:55]
    ds_read_b128 v[16:19], v9 offset:1488
    v_mfma_f32_16x16x32_bf16 v[52:55], v[244:247], v[164:167], v[52:55]
    ds_read_b128 v[20:23], v9 offset:448
    v_mfma_f32_16x16x32_bf16 v[56:59], v[236:239], v[144:147], v[56:59]
    ds_read_b64 v[138:139], v8 offset:1128
    v_mfma_f32_16x16x32_bf16 v[56:59], v[240:243], v[156:159], v[56:59]
    ds_read_b128 v[24:27], v9 offset:464
    v_mfma_f32_16x16x32_bf16 v[56:59], v[244:247], v[168:171], v[56:59]
    ds_read_b128 v[28:31], v9 offset:512
    v_mfma_f32_16x16x32_bf16 v[60:63], v[236:239], v[148:151], 0
    ds_read_b128 v[32:35], v9 offset:2496
    v_mfma_f32_16x16x32_bf16 v[60:63], v[240:243], v[160:163], v[60:63]
    v_mfma_f32_16x16x32_bf16 v[60:63], v[244:247], v[172:175], v[60:63]
    ds_read_b128 v[36:39], v9 offset:2432
    s_waitcnt lgkmcnt(11)
    v_mfma_f32_16x16x32_bf16 v[40:43], v[244:247], v[176:179], 0
    s_waitcnt lgkmcnt(8)
    v_mfma_f32_16x16x32_bf16 v[44:47], v[244:247], v[180:183], 0
    ds_read_b128 v[248:251], v9 offset:2368
    v_mfma_f32_16x16x32_bf16 v[184:187], v[252:255], v[224:227], 0
    v_cvt_pk_bf16_f32 v14, v52, v53
    v_cvt_pk_bf16_f32 v15, v54, v55
    v_mov_b32 v7, 4
    ds_write_b64 v10, v[14:15] offset:1536
    ds_write_b32 v11, v7
    v_mfma_f32_16x16x32_bf16 v[188:191], v[252:255], v[216:219], 0
    v_mfma_f32_16x16x32_bf16 v[192:195], v[252:255], v[220:223], 0
    v_mfma_f32_16x16x32_bf16 v[56:59], v[128:131], v[252:255], v[56:59]
    ds_read_b128 v[252:255], v9 offset:2304
    s_waitcnt lgkmcnt(10)
    v_mfma_f32_16x16x32_bf16 v[196:199], v[16:19], v[212:215], 0
    ds_read_b128 v[16:19], v9 offset:2240
    s_waitcnt lgkmcnt(10)
    v_mfma_f32_16x16x32_bf16 v[200:203], v[20:23], v[232:235], 0
    s_waitcnt lgkmcnt(9)
    v_mfma_f32_16x16x32_bf16 v[56:59], v[136:139], v[20:23], v[56:59]
    ds_read_b128 v[20:23], v9 offset:2176
    s_waitcnt lgkmcnt(9)
    v_mfma_f32_16x16x32_bf16 v[204:207], v[24:27], v[228:231], 0
    ds_read_b128 v[24:27], v9 offset:2112
    s_waitcnt lgkmcnt(9)
    v_mfma_f32_16x16x32_bf16 v[56:59], v[132:135], v[28:31], v[56:59]
    s_waitcnt lgkmcnt(8)
    v_mfma_f32_16x16x32_bf16 v[56:59], v[64:67], v[32:35], v[56:59]
    v_cvt_pk_bf16_f32 v238, v184, v185
    ds_read_b128 v[28:31], v9 offset:2048
    v_mfma_f32_16x16x32_bf16 v[60:63], v[96:99], v[32:35], v[60:63]
    v_cvt_pk_bf16_f32 v239, v186, v187
    s_waitcnt lgkmcnt(8)
    v_mfma_f32_16x16x32_bf16 v[56:59], v[68:71], v[36:39], v[56:59]
    v_cvt_pk_bf16_f32 v240, v188, v189
    v_mfma_f32_16x16x32_bf16 v[60:63], v[100:103], v[36:39], v[60:63]
    v_cvt_pk_bf16_f32 v241, v190, v191
    s_waitcnt lgkmcnt(7)
    v_mfma_f32_16x16x32_bf16 v[56:59], v[72:75], v[248:251], v[56:59]
    v_cvt_pk_bf16_f32 v242, v192, v193
    v_mfma_f32_16x16x32_bf16 v[60:63], v[104:107], v[248:251], v[60:63]
    v_cvt_pk_bf16_f32 v243, v194, v195
    s_waitcnt lgkmcnt(4)
    v_mfma_f32_16x16x32_bf16 v[56:59], v[76:79], v[252:255], v[56:59]
    v_cvt_pk_bf16_f32 v236, v196, v197
    v_mfma_f32_16x16x32_bf16 v[60:63], v[108:111], v[252:255], v[60:63]
    v_cvt_pk_bf16_f32 v237, v198, v199
    s_waitcnt lgkmcnt(3)
    v_mfma_f32_16x16x32_bf16 v[56:59], v[80:83], v[16:19], v[56:59]
    v_cvt_pk_bf16_f32 v246, v200, v201
    v_mfma_f32_16x16x32_bf16 v[60:63], v[112:115], v[16:19], v[60:63]
    v_cvt_pk_bf16_f32 v247, v202, v203
    s_waitcnt lgkmcnt(2)
    v_mfma_f32_16x16x32_bf16 v[56:59], v[84:87], v[20:23], v[56:59]
    v_cvt_pk_bf16_f32 v244, v204, v205
    v_mfma_f32_16x16x32_bf16 v[60:63], v[116:119], v[20:23], v[60:63]
    v_cvt_pk_bf16_f32 v245, v206, v207
    s_waitcnt lgkmcnt(1)
    v_mfma_f32_16x16x32_bf16 v[56:59], v[88:91], v[24:27], v[56:59]
    ds_read_b128 v[32:35], v9 offset:1984
    v_mfma_f32_16x16x32_bf16 v[60:63], v[120:123], v[24:27], v[60:63]
    s_waitcnt lgkmcnt(1)
    v_mfma_f32_16x16x32_bf16 v[56:59], v[92:95], v[28:31], v[56:59]
    v_mfma_f32_16x16x32_bf16 v[60:63], v[124:127], v[28:31], v[60:63]
    v_mfma_f32_16x16x32_bf16 v[56:59], v[236:239], v[140:143], v[56:59]
    ds_read_b128 v[36:39], v9 offset:2000
    v_mfma_f32_16x16x32_bf16 v[56:59], v[240:243], v[152:155], v[56:59]
    ds_read_b128 v[248:251], v9 offset:960
    v_mfma_f32_16x16x32_bf16 v[56:59], v[244:247], v[164:167], v[56:59]
    v_mfma_f32_16x16x32_bf16 v[60:63], v[236:239], v[144:147], v[60:63]
    ds_read_b128 v[252:255], v9 offset:976
    v_mfma_f32_16x16x32_bf16 v[60:63], v[240:243], v[156:159], v[60:63]
    ds_read_b128 v[16:19], v9 offset:1024
    v_mfma_f32_16x16x32_bf16 v[60:63], v[244:247], v[168:171], v[60:63]
    ds_read_b128 v[20:23], v9 offset:3008
    v_mfma_f32_16x16x32_bf16 v[40:43], v[236:239], v[148:151], v[40:43]
    v_mfma_f32_16x16x32_bf16 v[40:43], v[240:243], v[160:163], v[40:43]
    ds_read_b128 v[24:27], v9 offset:2944
    v_mfma_f32_16x16x32_bf16 v[40:43], v[244:247], v[172:175], v[40:43]
    v_mfma_f32_16x16x32_bf16 v[44:47], v[244:247], v[176:179], v[44:47]
    ds_read_b128 v[28:31], v9 offset:2880
    s_waitcnt lgkmcnt(7)
    v_mfma_f32_16x16x32_bf16 v[184:187], v[32:35], v[224:227], 0
    v_mfma_f32_16x16x32_bf16 v[188:191], v[32:35], v[216:219], 0
    v_cvt_pk_bf16_f32 v12, v56, v57
    v_cvt_pk_bf16_f32 v13, v58, v59
    v_mov_b32 v7, 5
    ds_write_b64 v10, v[12:13] offset:2048
    ds_write_b32 v11, v7
    v_mfma_f32_16x16x32_bf16 v[192:195], v[32:35], v[220:223], 0
    v_mfma_f32_16x16x32_bf16 v[60:63], v[128:131], v[32:35], v[60:63]
    ds_read_b128 v[32:35], v9 offset:2816
    s_waitcnt lgkmcnt(9)
    v_mfma_f32_16x16x32_bf16 v[196:199], v[36:39], v[212:215], 0
    ds_read_b128 v[36:39], v9 offset:2752
    s_waitcnt lgkmcnt(9)
    v_mfma_f32_16x16x32_bf16 v[200:203], v[248:251], v[232:235], 0
    v_mfma_f32_16x16x32_bf16 v[60:63], v[136:139], v[248:251], v[60:63]
    ds_read_b128 v[248:251], v9 offset:2688
    s_waitcnt lgkmcnt(9)
    v_mfma_f32_16x16x32_bf16 v[204:207], v[252:255], v[228:231], 0
    ds_read_b128 v[252:255], v9 offset:2624
    s_waitcnt lgkmcnt(9)
    v_mfma_f32_16x16x32_bf16 v[60:63], v[132:135], v[16:19], v[60:63]
    s_waitcnt lgkmcnt(8)
    v_mfma_f32_16x16x32_bf16 v[60:63], v[64:67], v[20:23], v[60:63]
    v_cvt_pk_bf16_f32 v238, v184, v185
    ds_read_b128 v[16:19], v9 offset:2560
    v_mfma_f32_16x16x32_bf16 v[40:43], v[96:99], v[20:23], v[40:43]
    v_cvt_pk_bf16_f32 v239, v186, v187
    s_waitcnt lgkmcnt(8)
    v_mfma_f32_16x16x32_bf16 v[60:63], v[68:71], v[24:27], v[60:63]
    v_cvt_pk_bf16_f32 v240, v188, v189
    v_mfma_f32_16x16x32_bf16 v[40:43], v[100:103], v[24:27], v[40:43]
    v_cvt_pk_bf16_f32 v241, v190, v191
    s_waitcnt lgkmcnt(7)
    v_mfma_f32_16x16x32_bf16 v[60:63], v[72:75], v[28:31], v[60:63]
    v_cvt_pk_bf16_f32 v242, v192, v193
    v_mfma_f32_16x16x32_bf16 v[40:43], v[104:107], v[28:31], v[40:43]
    v_cvt_pk_bf16_f32 v243, v194, v195
    s_waitcnt lgkmcnt(4)
    v_mfma_f32_16x16x32_bf16 v[60:63], v[76:79], v[32:35], v[60:63]
    v_cvt_pk_bf16_f32 v236, v196, v197
    v_mfma_f32_16x16x32_bf16 v[40:43], v[108:111], v[32:35], v[40:43]
    v_cvt_pk_bf16_f32 v237, v198, v199
    s_waitcnt lgkmcnt(3)
    v_mfma_f32_16x16x32_bf16 v[60:63], v[80:83], v[36:39], v[60:63]
    v_cvt_pk_bf16_f32 v246, v200, v201
    v_mfma_f32_16x16x32_bf16 v[40:43], v[112:115], v[36:39], v[40:43]
    v_cvt_pk_bf16_f32 v247, v202, v203
    s_waitcnt lgkmcnt(2)
    v_mfma_f32_16x16x32_bf16 v[60:63], v[84:87], v[248:251], v[60:63]
    v_cvt_pk_bf16_f32 v244, v204, v205
    v_mfma_f32_16x16x32_bf16 v[40:43], v[116:119], v[248:251], v[40:43]
    v_cvt_pk_bf16_f32 v245, v206, v207
    ds_read_b128 v[20:23], v9 offset:2496
    s_waitcnt lgkmcnt(2)
    v_mfma_f32_16x16x32_bf16 v[60:63], v[88:91], v[252:255], v[60:63]
    v_mfma_f32_16x16x32_bf16 v[40:43], v[120:123], v[252:255], v[40:43]
    s_waitcnt lgkmcnt(1)
    v_mfma_f32_16x16x32_bf16 v[60:63], v[92:95], v[16:19], v[60:63]
    v_mfma_f32_16x16x32_bf16 v[40:43], v[124:127], v[16:19], v[40:43]
    ds_read_b128 v[24:27], v9 offset:2512
    v_mfma_f32_16x16x32_bf16 v[60:63], v[236:239], v[140:143], v[60:63]
    ds_read_b128 v[28:31], v9 offset:1472
    v_mfma_f32_16x16x32_bf16 v[60:63], v[240:243], v[152:155], v[60:63]
    v_mfma_f32_16x16x32_bf16 v[60:63], v[244:247], v[164:167], v[60:63]
    ds_read_b128 v[32:35], v9 offset:1488
    v_mfma_f32_16x16x32_bf16 v[40:43], v[236:239], v[144:147], v[40:43]
    ds_read_b128 v[36:39], v9 offset:1536
    v_mfma_f32_16x16x32_bf16 v[40:43], v[240:243], v[156:159], v[40:43]
    ds_read_b128 v[248:251], v9 offset:3520
    v_mfma_f32_16x16x32_bf16 v[40:43], v[244:247], v[168:171], v[40:43]
    v_mfma_f32_16x16x32_bf16 v[44:47], v[236:239], v[148:151], v[44:47]
    ds_read_b128 v[252:255], v9 offset:3456
    v_mfma_f32_16x16x32_bf16 v[44:47], v[240:243], v[160:163], v[44:47]
    v_mfma_f32_16x16x32_bf16 v[44:47], v[244:247], v[172:175], v[44:47]
    ds_read_b128 v[16:19], v9 offset:3392
    s_waitcnt lgkmcnt(7)
    v_mfma_f32_16x16x32_bf16 v[184:187], v[20:23], v[224:227], 0
    v_mfma_f32_16x16x32_bf16 v[188:191], v[20:23], v[216:219], 0
    v_mfma_f32_16x16x32_bf16 v[192:195], v[20:23], v[220:223], 0
    v_cvt_pk_bf16_f32 v14, v60, v61
    v_cvt_pk_bf16_f32 v15, v62, v63
    v_mov_b32 v7, 6
    ds_write_b64 v10, v[14:15] offset:2560
    ds_write_b32 v11, v7
    v_mfma_f32_16x16x32_bf16 v[40:43], v[128:131], v[20:23], v[40:43]
    ds_read_b128 v[20:23], v9 offset:3328
    s_waitcnt lgkmcnt(9)
    v_mfma_f32_16x16x32_bf16 v[196:199], v[24:27], v[212:215], 0
    ds_read_b128 v[24:27], v9 offset:3264
    s_waitcnt lgkmcnt(9)
    v_mfma_f32_16x16x32_bf16 v[200:203], v[28:31], v[232:235], 0
    v_mfma_f32_16x16x32_bf16 v[40:43], v[136:139], v[28:31], v[40:43]
    ds_read_b128 v[28:31], v9 offset:3200
    s_waitcnt lgkmcnt(9)
    v_mfma_f32_16x16x32_bf16 v[204:207], v[32:35], v[228:231], 0
    ds_read_b128 v[32:35], v9 offset:3136
    s_waitcnt lgkmcnt(9)
    v_mfma_f32_16x16x32_bf16 v[40:43], v[132:135], v[36:39], v[40:43]
    s_waitcnt lgkmcnt(8)
    v_mfma_f32_16x16x32_bf16 v[40:43], v[64:67], v[248:251], v[40:43]
    v_cvt_pk_bf16_f32 v238, v184, v185
    ds_read_b128 v[36:39], v9 offset:3072
    v_mfma_f32_16x16x32_bf16 v[44:47], v[96:99], v[248:251], v[44:47]
    v_cvt_pk_bf16_f32 v239, v186, v187
    s_waitcnt lgkmcnt(8)
    v_mfma_f32_16x16x32_bf16 v[40:43], v[68:71], v[252:255], v[40:43]
    v_cvt_pk_bf16_f32 v240, v188, v189
    v_mfma_f32_16x16x32_bf16 v[44:47], v[100:103], v[252:255], v[44:47]
    v_cvt_pk_bf16_f32 v241, v190, v191
    s_waitcnt lgkmcnt(7)
    v_mfma_f32_16x16x32_bf16 v[40:43], v[72:75], v[16:19], v[40:43]
    v_cvt_pk_bf16_f32 v242, v192, v193
    v_mfma_f32_16x16x32_bf16 v[44:47], v[104:107], v[16:19], v[44:47]
    v_cvt_pk_bf16_f32 v243, v194, v195
    s_waitcnt lgkmcnt(4)
    v_mfma_f32_16x16x32_bf16 v[40:43], v[76:79], v[20:23], v[40:43]
    v_cvt_pk_bf16_f32 v236, v196, v197
    v_mfma_f32_16x16x32_bf16 v[44:47], v[108:111], v[20:23], v[44:47]
    v_cvt_pk_bf16_f32 v237, v198, v199
    s_waitcnt lgkmcnt(3)
    v_mfma_f32_16x16x32_bf16 v[40:43], v[80:83], v[24:27], v[40:43]
    v_cvt_pk_bf16_f32 v246, v200, v201
    ds_read_b128 v[248:251], v9 offset:3008
    v_mfma_f32_16x16x32_bf16 v[44:47], v[112:115], v[24:27], v[44:47]
    v_cvt_pk_bf16_f32 v247, v202, v203
    s_waitcnt lgkmcnt(3)
    v_mfma_f32_16x16x32_bf16 v[40:43], v[84:87], v[28:31], v[40:43]
    v_cvt_pk_bf16_f32 v244, v204, v205
    v_mfma_f32_16x16x32_bf16 v[44:47], v[116:119], v[28:31], v[44:47]
    v_cvt_pk_bf16_f32 v245, v206, v207
    s_waitcnt lgkmcnt(2)
    v_mfma_f32_16x16x32_bf16 v[40:43], v[88:91], v[32:35], v[40:43]
    ds_read_b128 v[252:255], v9 offset:3024
    v_mfma_f32_16x16x32_bf16 v[44:47], v[120:123], v[32:35], v[44:47]
    ds_read_b128 v[16:19], v9 offset:1984
    s_waitcnt lgkmcnt(3)
    v_mfma_f32_16x16x32_bf16 v[40:43], v[92:95], v[36:39], v[40:43]
    v_mfma_f32_16x16x32_bf16 v[44:47], v[124:127], v[36:39], v[44:47]
    ds_read_b128 v[20:23], v9 offset:2000
    v_mfma_f32_16x16x32_bf16 v[40:43], v[236:239], v[140:143], v[40:43]
    ds_read_b128 v[24:27], v9 offset:2048
    v_mfma_f32_16x16x32_bf16 v[40:43], v[240:243], v[152:155], v[40:43]
    ds_read_b128 v[28:31], v9 offset:4032
    v_mfma_f32_16x16x32_bf16 v[40:43], v[244:247], v[164:167], v[40:43]
    ds_read_b128 v[32:35], v9 offset:3968
    v_mfma_f32_16x16x32_bf16 v[44:47], v[236:239], v[144:147], v[44:47]
    ds_read_b128 v[36:39], v9 offset:3904
    v_mfma_f32_16x16x32_bf16 v[44:47], v[240:243], v[156:159], v[44:47]
    v_mfma_f32_16x16x32_bf16 v[44:47], v[244:247], v[168:171], v[44:47]
    s_waitcnt lgkmcnt(7)
    v_mfma_f32_16x16x32_bf16 v[184:187], v[248:251], v[224:227], 0
    v_mfma_f32_16x16x32_bf16 v[188:191], v[248:251], v[216:219], 0
    v_mfma_f32_16x16x32_bf16 v[192:195], v[248:251], v[220:223], 0
    v_mfma_f32_16x16x32_bf16 v[44:47], v[128:131], v[248:251], v[44:47]
    ds_read_b128 v[248:251], v9 offset:3840
    s_waitcnt lgkmcnt(7)
    v_mfma_f32_16x16x32_bf16 v[196:199], v[252:255], v[212:215], 0
    ds_read_b128 v[252:255], v9 offset:3776
    s_waitcnt lgkmcnt(7)
    v_mfma_f32_16x16x32_bf16 v[200:203], v[16:19], v[232:235], 0
    v_cvt_pk_bf16_f32 v12, v40, v41
    v_cvt_pk_bf16_f32 v13, v42, v43
    v_mov_b32 v7, 7
    ds_write_b64 v10, v[12:13] offset:3072
    ds_write_b32 v11, v7
    v_mfma_f32_16x16x32_bf16 v[44:47], v[136:139], v[16:19], v[44:47]
    ds_read_b128 v[16:19], v9 offset:3712
    s_waitcnt lgkmcnt(9)
    v_mfma_f32_16x16x32_bf16 v[204:207], v[20:23], v[228:231], 0
    ds_read_b128 v[20:23], v9 offset:3648
    s_waitcnt lgkmcnt(9)
    v_mfma_f32_16x16x32_bf16 v[44:47], v[132:135], v[24:27], v[44:47]
    ds_read_b128 v[24:27], v9 offset:3584
    s_waitcnt lgkmcnt(9)
    v_mfma_f32_16x16x32_bf16 v[44:47], v[64:67], v[28:31], v[44:47]
    v_cvt_pk_bf16_f32 v238, v184, v185
    v_cvt_pk_bf16_f32 v239, v186, v187
    s_waitcnt lgkmcnt(8)
    v_mfma_f32_16x16x32_bf16 v[44:47], v[68:71], v[32:35], v[44:47]
    v_cvt_pk_bf16_f32 v240, v188, v189
    v_cvt_pk_bf16_f32 v241, v190, v191
    s_waitcnt lgkmcnt(7)
    v_mfma_f32_16x16x32_bf16 v[44:47], v[72:75], v[36:39], v[44:47]
    v_cvt_pk_bf16_f32 v242, v192, v193
    v_cvt_pk_bf16_f32 v243, v194, v195
    s_waitcnt lgkmcnt(6)
    v_mfma_f32_16x16x32_bf16 v[44:47], v[76:79], v[248:251], v[44:47]
    s_waitcnt lgkmcnt(5)
    v_mfma_f32_16x16x32_bf16 v[44:47], v[80:83], v[252:255], v[44:47]
    v_cvt_pk_bf16_f32 v236, v196, v197
    v_cvt_pk_bf16_f32 v237, v198, v199
    s_waitcnt lgkmcnt(2)
    v_mfma_f32_16x16x32_bf16 v[44:47], v[84:87], v[16:19], v[44:47]
    v_cvt_pk_bf16_f32 v246, v200, v201
    v_cvt_pk_bf16_f32 v247, v202, v203
    s_waitcnt lgkmcnt(1)
    v_mfma_f32_16x16x32_bf16 v[44:47], v[88:91], v[20:23], v[44:47]
    s_waitcnt lgkmcnt(0)
    v_mfma_f32_16x16x32_bf16 v[44:47], v[92:95], v[24:27], v[44:47]
    v_cvt_pk_bf16_f32 v244, v204, v205
    v_cvt_pk_bf16_f32 v245, v206, v207
    v_mfma_f32_16x16x32_bf16 v[44:47], v[236:239], v[140:143], v[44:47]
    v_mfma_f32_16x16x32_bf16 v[44:47], v[240:243], v[152:155], v[44:47]
    v_mfma_f32_16x16x32_bf16 v[44:47], v[244:247], v[164:167], v[44:47]
    s_nop 7
    v_cvt_pk_bf16_f32 v14, v44, v45
    v_cvt_pk_bf16_f32 v15, v46, v47
    ds_write_b64 v10, v[14:15] offset:3584
    s_waitcnt lgkmcnt(0)
    s_barrier
    v_mov_b32 v1, s64
    v_mov_b32 v2, 0
    s_mov_b64 exec, 1
    global_store_dword v1, v2, s[36:37]
    s_mov_b64 exec, -1
    v_mov_b32 v1, s63
    s_mov_b64 exec, 1
    global_store_dword v1, v2, s[36:37]
    s_endpgm
L_B0:
    s_cmp_eq_u32 s39, 0
    s_cbranch_scc0 L_BH0
    v_and_b32 v4, 15, v0
    v_lshrrev_b32 v5, 4, v0
    s_lshl_b32 s55, s6, 4
    s_lshl_b32 s97, s4, 2
    s_add_u32 s55, s55, s97
    v_add_u32 v5, s55, v5
    v_mul_u32_u24 v1, 7168, v5
    v_lshl_add_u32 v1, v4, 3, v1
    s_lshl_b32 s55, s7, 7
    v_add_u32 v1, s55, v1
    s_lshl_b32 s55, s7, 9
    v_lshl_add_u32 v6, v4, 5, s55
    v_subrev_u32 v2, 2688, v1
    v_add_u32 v3, 3584, v1
    s_movk_i32 s96, 4480
    s_mov_b32 s46, 0x1c0000
    s_mov_b32 s47, 0x20000
    s_waitcnt lgkmcnt(0)
    s_mov_b32 s44, s24
    s_and_b32 s45, s25, 0xffff
    buffer_load_dwordx2 v[8:9], v2, s[44:47], 0 offen offset:0 nt
    buffer_load_dwordx2 v[10:11], v2, s[44:47], 0 offen offset:896 nt
    buffer_load_dwordx2 v[12:13], v2, s[44:47], 0 offen offset:1792 nt
    buffer_load_dwordx2 v[14:15], v1, s[44:47], 0 offen offset:0 nt
    buffer_load_dwordx2 v[16:17], v1, s[44:47], 0 offen offset:896 nt
    buffer_load_dwordx2 v[18:19], v1, s[44:47], 0 offen offset:1792 nt
    buffer_load_dwordx2 v[20:21], v1, s[44:47], 0 offen offset:2688 nt
    buffer_load_dwordx2 v[22:23], v1, s[44:47], 0 offen offset:3584 nt
    buffer_load_dwordx2 v[24:25], v1, s[44:47], s96 offen offset:0 nt
    buffer_load_dwordx2 v[26:27], v1, s[44:47], s96 offen offset:896 nt
    buffer_load_dwordx2 v[28:29], v1, s[44:47], s96 offen offset:1792 nt
    global_load_dwordx4 v[48:51], v6, s[28:29]
    global_load_dwordx4 v[52:55], v6, s[28:29] offset:16
    global_load_dwordx2 v[30:31], v3, s[26:27] offset:-3584 nt
    global_load_dwordx2 v[32:33], v3, s[26:27] offset:-2688 nt
    global_load_dwordx2 v[34:35], v3, s[26:27] offset:-1792 nt
    global_load_dwordx2 v[36:37], v3, s[26:27] offset:-896 nt
    global_load_dwordx2 v[38:39], v3, s[26:27] offset:0 nt
    global_load_dwordx2 v[40:41], v3, s[26:27] offset:896 nt
    global_load_dwordx2 v[42:43], v3, s[26:27] offset:1792 nt
    global_load_dwordx2 v[44:45], v3, s[26:27] offset:2688 nt
    s_branch L_BM1
L_BH0:
    s_lshl_b32 s96, s5, 12
    s_lshl_b32 s97, s4, 12
    s_add_u32 s96, s96, s97
    v_lshlrev_b32 v1, 4, v0
    v_subrev_u32 v2, 8, v1
    s_lshl_b32 s55, s5, 1
    s_movk_i32 s50, 4096
    s_mov_b32 s51, 0x20000
    s_waitcnt lgkmcnt(0)
    s_add_u32 s48, s30, s96
    s_addc_u32 s49, s31, 0
    s_and_b32 s49, s49, 0xffff
    buffer_load_dwordx2 v[64:65], v2, s[48:51], 0 offen nt
    buffer_load_dwordx4 v[66:69], v1, s[48:51], 0 offen nt
    buffer_load_dwordx2 v[70:71], v1, s[48:51], 0 offen offset:1016 nt
    buffer_load_dwordx4 v[72:75], v1, s[48:51], 0 offen offset:1024 nt
    buffer_load_dwordx2 v[76:77], v1, s[48:51], 0 offen offset:2040 nt
    buffer_load_dwordx4 v[78:81], v1, s[48:51], 0 offen offset:2048 nt
    buffer_load_dwordx2 v[82:83], v1, s[48:51], 0 offen offset:3064 nt
    buffer_load_dwordx4 v[84:87], v1, s[48:51], 0 offen offset:3072 nt
    s_load_dwordx2 s[72:73], s[32:33], s55
    s_branch L_BH1
L_BM1:
    s_mov_b32 s52, 0x05040100
    s_mov_b32 s53, 0x07060302
    s_mov_b32 s54, 0xffff
    s_add_u32 s68, s36, 1835008
    s_addc_u32 s69, s37, 0
    s_and_b32 s69, s69, 0xffff
    s_mov_b32 s70, 0x1c0000
    s_mov_b32 s71, 0x20000
    s_lshl_b32 s55, s7, 18
    v_lshlrev_b32 v56, 14, v4
    v_lshl_add_u32 v56, v5, 4, v56
    v_add_u32 v56, s55, v56
    s_lshl_b32 s55, s7, 18
    s_lshl_b32 s97, s6, 14
    s_add_u32 s55, s55, s97
    s_lshl_b32 s97, s4, 12
    s_add_u32 s55, s55, s97
    v_lshl_add_u32 v57, v0, 4, s55
    v_lshl_add_u32 v254, v0, 6, s55
    s_movk_i32 s81, 4096
    s_movk_i32 s82, 8192
    s_movk_i32 s83, 12288
    s_lshl_b32 s55, s7, 8
    s_add_u32 s55, s55, 6293248
    v_lshl_add_u32 v60, v0, 2, s55
    s_lshl_b32 s64, s6, 4
    s_lshl_b32 s97, s4, 2
    s_add_u32 s64, s64, s97
    s_add_u32 s64, s64, s55
    v_mov_b32 v61, s64
    s_getreg_b32 s65, hwreg(HW_REG_XCC_ID, 0, 4)
    s_add_u32 s65, s65, 1
    s_mul_i32 s65, s65, 0x9e3779b9
    s_xor_b32 s65, s65, 0x6b8b4567
    v_mov_b32 v62, s65
    global_load_dword v255, v60, s[36:37] sc1
    s_mul_i32 s55, s4, 4608
    s_add_u32 s55, s55, 110080
    s_mov_b32 m0, s55
    s_sub_u32 s96, m0, 512
    v_lshl_add_u32 v4, v0, 3, s96
    v_mov_b32 v46, 0
    v_mov_b32 v47, 0
    ds_write_b64 v4, v[46:47]
    s_waitcnt vmcnt(21)
    v_lshlrev_b32 v64, 16, v8
    v_and_b32 v65, 0xffff0000, v8
    s_waitcnt vmcnt(20)
    v_lshlrev_b32 v66, 16, v10
    v_and_b32 v67, 0xffff0000, v10
    s_waitcnt vmcnt(19)
    v_lshlrev_b32 v68, 16, v12
    v_and_b32 v69, 0xffff0000, v12
    s_waitcnt vmcnt(18)
    v_lshlrev_b32 v70, 16, v14
    v_and_b32 v71, 0xffff0000, v14
    s_waitcnt vmcnt(17)
    v_lshlrev_b32 v72, 16, v16
    v_and_b32 v73, 0xffff0000, v16
    s_waitcnt vmcnt(16)
    v_lshlrev_b32 v74, 16, v18
    v_and_b32 v75, 0xffff0000, v18
    s_waitcnt vmcnt(15)
    v_lshlrev_b32 v76, 16, v20
    v_and_b32 v77, 0xffff0000, v20
    s_waitcnt vmcnt(14)
    v_lshlrev_b32 v78, 16, v22
    v_and_b32 v79, 0xffff0000, v22
    s_waitcnt vmcnt(13)
    v_lshlrev_b32 v80, 16, v24
    v_and_b32 v81, 0xffff0000, v24
    s_waitcnt vmcnt(12)
    v_lshlrev_b32 v82, 16, v26
    v_and_b32 v83, 0xffff0000, v26
    s_waitcnt vmcnt(11)
    v_lshlrev_b32 v84, 16, v28
    v_and_b32 v85, 0xffff0000, v28
    v_lshlrev_b32 v160, 16, v9
    v_and_b32 v161, 0xffff0000, v9
    v_lshlrev_b32 v162, 16, v11
    v_and_b32 v163, 0xffff0000, v11
    v_lshlrev_b32 v164, 16, v13
    v_and_b32 v165, 0xffff0000, v13
    v_lshlrev_b32 v166, 16, v15
    v_and_b32 v167, 0xffff0000, v15
    v_lshlrev_b32 v168, 16, v17
    v_and_b32 v169, 0xffff0000, v17
    v_lshlrev_b32 v170, 16, v19
    v_and_b32 v171, 0xffff0000, v19
    v_lshlrev_b32 v172, 16, v21
    v_and_b32 v173, 0xffff0000, v21
    v_lshlrev_b32 v174, 16, v23
    v_and_b32 v175, 0xffff0000, v23
    v_lshlrev_b32 v176, 16, v25
    v_and_b32 v177, 0xffff0000, v25
    v_lshlrev_b32 v178, 16, v27
    v_and_b32 v179, 0xffff0000, v27
    v_lshlrev_b32 v180, 16, v29
    v_and_b32 v181, 0xffff0000, v29
    s_waitcnt vmcnt(10)
    v_lshlrev_b32 v144, 16, v48
    v_and_b32 v146, 0xffff0000, v48
    v_lshlrev_b32 v148, 16, v49
    v_and_b32 v150, 0xffff0000, v49
    v_lshlrev_b32 v145, 16, v50
    v_and_b32 v147, 0xffff0000, v50
    v_lshlrev_b32 v149, 16, v51
    v_and_b32 v151, 0xffff0000, v51
    s_waitcnt vmcnt(9)
    v_lshlrev_b32 v152, 16, v52
    v_and_b32 v154, 0xffff0000, v52
    v_lshlrev_b32 v156, 16, v53
    v_and_b32 v158, 0xffff0000, v53
    v_lshlrev_b32 v153, 16, v54
    v_and_b32 v155, 0xffff0000, v54
    v_lshlrev_b32 v157, 16, v55
    v_and_b32 v159, 0xffff0000, v55
    v_pk_mul_f32 v[96:97], v[64:65], v[150:151]
    v_pk_mul_f32 v[98:99], v[66:67], v[150:151]
    v_pk_mul_f32 v[100:101], v[68:69], v[150:151]
    v_pk_mul_f32 v[102:103], v[70:71], v[150:151]
    v_pk_mul_f32 v[104:105], v[72:73], v[150:151]
    v_pk_mul_f32 v[106:107], v[74:75], v[150:151]
    v_pk_mul_f32 v[108:109], v[76:77], v[150:151]
    v_pk_mul_f32 v[110:111], v[78:79], v[150:151]
    v_pk_mul_f32 v[112:113], v[160:161], v[158:159]
    v_pk_mul_f32 v[114:115], v[162:163], v[158:159]
    v_pk_mul_f32 v[116:117], v[164:165], v[158:159]
    v_pk_mul_f32 v[118:119], v[166:167], v[158:159]
    v_pk_mul_f32 v[120:121], v[168:169], v[158:159]
    v_pk_mul_f32 v[122:123], v[170:171], v[158:159]
    v_pk_mul_f32 v[124:125], v[172:173], v[158:159]
    v_pk_mul_f32 v[126:127], v[174:175], v[158:159]
    v_pk_fma_f32 v[96:97], v[66:67], v[148:149], v[96:97]
    v_pk_fma_f32 v[98:99], v[68:69], v[148:149], v[98:99]
    v_pk_fma_f32 v[100:101], v[70:71], v[148:149], v[100:101]
    v_pk_fma_f32 v[102:103], v[72:73], v[148:149], v[102:103]
    v_pk_fma_f32 v[104:105], v[74:75], v[148:149], v[104:105]
    v_pk_fma_f32 v[106:107], v[76:77], v[148:149], v[106:107]
    v_pk_fma_f32 v[108:109], v[78:79], v[148:149], v[108:109]
    v_pk_fma_f32 v[110:111], v[80:81], v[148:149], v[110:111]
    v_pk_fma_f32 v[112:113], v[162:163], v[156:157], v[112:113]
    v_pk_fma_f32 v[114:115], v[164:165], v[156:157], v[114:115]
    v_pk_fma_f32 v[116:117], v[166:167], v[156:157], v[116:117]
    v_pk_fma_f32 v[118:119], v[168:169], v[156:157], v[118:119]
    v_pk_fma_f32 v[120:121], v[170:171], v[156:157], v[120:121]
    v_pk_fma_f32 v[122:123], v[172:173], v[156:157], v[122:123]
    v_pk_fma_f32 v[124:125], v[174:175], v[156:157], v[124:125]
    v_pk_fma_f32 v[126:127], v[176:177], v[156:157], v[126:127]
    v_pk_fma_f32 v[96:97], v[68:69], v[146:147], v[96:97]
    v_pk_fma_f32 v[98:99], v[70:71], v[146:147], v[98:99]
    v_pk_fma_f32 v[100:101], v[72:73], v[146:147], v[100:101]
    v_pk_fma_f32 v[102:103], v[74:75], v[146:147], v[102:103]
    v_pk_fma_f32 v[104:105], v[76:77], v[146:147], v[104:105]
    v_pk_fma_f32 v[106:107], v[78:79], v[146:147], v[106:107]
    v_pk_fma_f32 v[108:109], v[80:81], v[146:147], v[108:109]
    v_pk_fma_f32 v[110:111], v[82:83], v[146:147], v[110:111]
    v_pk_fma_f32 v[112:113], v[164:165], v[154:155], v[112:113]
    v_pk_fma_f32 v[114:115], v[166:167], v[154:155], v[114:115]
    v_pk_fma_f32 v[116:117], v[168:169], v[154:155], v[116:117]
    v_pk_fma_f32 v[118:119], v[170:171], v[154:155], v[118:119]
    v_pk_fma_f32 v[120:121], v[172:173], v[154:155], v[120:121]
    v_pk_fma_f32 v[122:123], v[174:175], v[154:155], v[122:123]
    v_pk_fma_f32 v[124:125], v[176:177], v[154:155], v[124:125]
    v_pk_fma_f32 v[126:127], v[178:179], v[154:155], v[126:127]
    v_pk_fma_f32 v[96:97], v[70:71], v[144:145], v[96:97]
    v_pk_fma_f32 v[98:99], v[72:73], v[144:145], v[98:99]
    v_pk_fma_f32 v[100:101], v[74:75], v[144:145], v[100:101]
    v_pk_fma_f32 v[102:103], v[76:77], v[144:145], v[102:103]
    v_pk_fma_f32 v[104:105], v[78:79], v[144:145], v[104:105]
    v_pk_fma_f32 v[106:107], v[80:81], v[144:145], v[106:107]
    v_pk_fma_f32 v[108:109], v[82:83], v[144:145], v[108:109]
    v_pk_fma_f32 v[110:111], v[84:85], v[144:145], v[110:111]
    v_pk_fma_f32 v[112:113], v[166:167], v[152:153], v[112:113]
    v_pk_fma_f32 v[114:115], v[168:169], v[152:153], v[114:115]
    v_pk_fma_f32 v[116:117], v[170:171], v[152:153], v[116:117]
    v_pk_fma_f32 v[118:119], v[172:173], v[152:153], v[118:119]
    v_pk_fma_f32 v[120:121], v[174:175], v[152:153], v[120:121]
    v_pk_fma_f32 v[122:123], v[176:177], v[152:153], v[122:123]
    v_pk_fma_f32 v[124:125], v[178:179], v[152:153], v[124:125]
    v_pk_fma_f32 v[126:127], v[180:181], v[152:153], v[126:127]
    s_waitcnt vmcnt(8)
    v_lshlrev_b32 v86, 16, v30
    v_and_b32 v87, 0xffff0000, v30
    v_pk_mul_f32 v[96:97], v[96:97], v[86:87]
    v_lshlrev_b32 v88, 16, v31
    v_and_b32 v89, 0xffff0000, v31
    v_pk_mul_f32 v[112:113], v[112:113], v[88:89]
    s_waitcnt vmcnt(7)
    v_lshlrev_b32 v90, 16, v32
    v_and_b32 v91, 0xffff0000, v32
    v_pk_mul_f32 v[98:99], v[98:99], v[90:91]
    v_lshlrev_b32 v92, 16, v33
    v_and_b32 v93, 0xffff0000, v33
    v_pk_mul_f32 v[114:115], v[114:115], v[92:93]
    v_cvt_pk_bf16_f32 v128, v96, v98
    v_cvt_pk_bf16_f32 v132, v97, v99
    v_cvt_pk_bf16_f32 v136, v112, v114
    v_cvt_pk_bf16_f32 v140, v113, v115
    s_waitcnt vmcnt(6)
    v_lshlrev_b32 v86, 16, v34
    v_and_b32 v87, 0xffff0000, v34
    v_pk_mul_f32 v[100:101], v[100:101], v[86:87]
    v_lshlrev_b32 v88, 16, v35
    v_and_b32 v89, 0xffff0000, v35
    v_pk_mul_f32 v[116:117], v[116:117], v[88:89]
    s_waitcnt vmcnt(5)
    v_lshlrev_b32 v90, 16, v36
    v_and_b32 v91, 0xffff0000, v36
    v_pk_mul_f32 v[102:103], v[102:103], v[90:91]
    v_lshlrev_b32 v92, 16, v37
    v_and_b32 v93, 0xffff0000, v37
    v_pk_mul_f32 v[118:119], v[118:119], v[92:93]
    v_cvt_pk_bf16_f32 v129, v100, v102
    v_cvt_pk_bf16_f32 v133, v101, v103
    v_cvt_pk_bf16_f32 v137, v116, v118
    v_cvt_pk_bf16_f32 v141, v117, v119
    s_waitcnt vmcnt(4)
    v_lshlrev_b32 v86, 16, v38
    v_and_b32 v87, 0xffff0000, v38
    v_pk_mul_f32 v[104:105], v[104:105], v[86:87]
    v_lshlrev_b32 v88, 16, v39
    v_and_b32 v89, 0xffff0000, v39
    v_pk_mul_f32 v[120:121], v[120:121], v[88:89]
    s_waitcnt vmcnt(3)
    v_lshlrev_b32 v90, 16, v40
    v_and_b32 v91, 0xffff0000, v40
    v_pk_mul_f32 v[106:107], v[106:107], v[90:91]
    v_lshlrev_b32 v92, 16, v41
    v_and_b32 v93, 0xffff0000, v41
    v_pk_mul_f32 v[122:123], v[122:123], v[92:93]
    v_cvt_pk_bf16_f32 v130, v104, v106
    v_cvt_pk_bf16_f32 v134, v105, v107
    v_cvt_pk_bf16_f32 v138, v120, v122
    v_cvt_pk_bf16_f32 v142, v121, v123
    s_waitcnt vmcnt(2)
    v_lshlrev_b32 v86, 16, v42
    v_and_b32 v87, 0xffff0000, v42
    v_pk_mul_f32 v[108:109], v[108:109], v[86:87]
    v_lshlrev_b32 v88, 16, v43
    v_and_b32 v89, 0xffff0000, v43
    v_pk_mul_f32 v[124:125], v[124:125], v[88:89]
    s_waitcnt vmcnt(1)
    v_lshlrev_b32 v90, 16, v44
    v_and_b32 v91, 0xffff0000, v44
    v_pk_mul_f32 v[110:111], v[110:111], v[90:91]
    v_lshlrev_b32 v92, 16, v45
    v_and_b32 v93, 0xffff0000, v45
    v_pk_mul_f32 v[126:127], v[126:127], v[92:93]
    v_cvt_pk_bf16_f32 v131, v108, v110
    v_cvt_pk_bf16_f32 v135, v109, v111
    v_cvt_pk_bf16_f32 v139, v124, v126
    v_cvt_pk_bf16_f32 v143, v125, v127
    buffer_store_dwordx4 v[128:131], v56, s[68:71], 0 offen nt
    buffer_store_dwordx4 v[132:135], v56, s[68:71], s81 offen nt
    buffer_store_dwordx4 v[136:139], v56, s[68:71], s82 offen nt
    buffer_store_dwordx4 v[140:143], v56, s[68:71], s83 offen nt
    v_and_b32 v15, 15, v0
    v_lshrrev_b32 v14, 4, v0
    v_and_b32 v13, 3, v15
    v_lshrrev_b32 v12, 2, v15
    v_mul_u32_u24 v16, 4160, v13
    v_lshl_add_u32 v16, v14, 4, v16
    v_lshlrev_b32 v17, 3, v12
    v_sub_u32 v16, v16, v17
    s_mul_i32 s55, s4, 16640
    s_add_u32 s55, s55, 24
    v_add_u32 v8, s55, v16
    v_lshlrev_b32 v16, 5, v15
    v_lshl_add_u32 v16, v14, 4, v16
    s_mul_i32 s55, s4, 4608
    s_add_u32 s55, s55, 109600
    v_add_u32 v9, s55, v16
    v_add_u32 v16, v14, v12
    v_and_b32 v16, 3, v16
    v_lshl_add_u32 v16, v13, 2, v16
    v_lshl_add_u32 v16, v12, 4, v16
    s_mul_i32 s55, s4, 4160
    s_add_u32 s55, s55, 66560
    v_lshl_add_u32 v10, v16, 3, s55
    s_lshl_b32 s55, s4, 2
    s_add_u32 s55, s55, 161280
    v_mov_b32 v11, s55
    s_waitcnt vmcnt(0)
    s_mov_b64 exec, 1
    global_store_dword v61, v62, s[36:37]
    s_mov_b64 exec, -1
    s_waitcnt lgkmcnt(0)
    s_barrier
    ds_read_b64 v[64:65], v8 offset:4032
    ds_read_b64 v[66:67], v8 offset:4040
    ds_read_b64 v[96:97], v8 offset:3520
    ds_read_b64 v[98:99], v8 offset:3528
    ds_read_b64 v[68:69], v8 offset:3968
    ds_read_b64 v[70:71], v8 offset:3976
    ds_read_b64 v[100:101], v8 offset:3456
    ds_read_b64 v[102:103], v8 offset:3464
    ds_read_b64 v[72:73], v8 offset:3904
    ds_read_b64 v[74:75], v8 offset:3912
    ds_read_b64 v[104:105], v8 offset:3392
    ds_read_b64 v[106:107], v8 offset:3400
    ds_read_b64 v[76:77], v8 offset:3840
    ds_read_b64 v[78:79], v8 offset:3848
    ds_read_b64 v[108:109], v8 offset:3328
    ds_read_b64 v[110:111], v8 offset:3336
    ds_read_b64 v[80:81], v8 offset:3776
    ds_read_b64 v[82:83], v8 offset:3784
    ds_read_b64 v[112:113], v8 offset:3264
    ds_read_b64 v[114:115], v8 offset:3272
    ds_read_b64 v[84:85], v8 offset:3712
    ds_read_b64 v[86:87], v8 offset:3720
    ds_read_b64 v[116:117], v8 offset:3200
    ds_read_b64 v[118:119], v8 offset:3208
    ds_read_b64 v[88:89], v8 offset:3648
    ds_read_b64 v[90:91], v8 offset:3656
    ds_read_b64 v[120:121], v8 offset:3136
    ds_read_b64 v[122:123], v8 offset:3144
    ds_read_b64 v[92:93], v8 offset:3584
    ds_read_b64 v[94:95], v8 offset:3592
    ds_read_b64 v[124:125], v8 offset:3072
    ds_read_b64 v[126:127], v8 offset:3080
    s_movk_i32 s66, 64
L_B_POLL:
    s_sub_u32 s66, s66, 1
    s_cbranch_scc1 L_B_FAIL
    global_load_dword v16, v60, s[36:37] sc1
    s_waitcnt vmcnt(0)
    v_cmp_ne_u32 vcc, s65, v16
    s_nop 1
    s_cbranch_vccnz L_B_POLL
    buffer_load_dwordx4 v57, s[68:71], 0 offen offset:0 sc1 nt lds
    buffer_load_dwordx4 v57, s[68:71], 0 offen offset:1024 sc1 nt lds
    buffer_load_dwordx4 v57, s[68:71], 0 offen offset:2048 sc1 nt lds
    buffer_load_dwordx4 v57, s[68:71], 0 offen offset:3072 sc1 nt lds
L_B_GOT:
    v_mov_b32 v7, 1
    ds_write_b32 v11, v7
    ds_read_b64 v[128:129], v8 offset:3008
    ds_read_b64 v[130:131], v8 offset:3016
    ds_read_b64 v[160:161], v8 offset:2496
    ds_read_b64 v[162:163], v8 offset:2504
    ds_read_b64 v[192:193], v8 offset:1984
    ds_read_b64 v[194:195], v8 offset:1992
    ds_read_b64 v[224:225], v8 offset:1472
    ds_read_b64 v[226:227], v8 offset:1480
    ds_read_b64 v[132:133], v8 offset:2944
    ds_read_b64 v[134:135], v8 offset:2952
    ds_read_b64 v[164:165], v8 offset:2432
    ds_read_b64 v[166:167], v8 offset:2440
    ds_read_b64 v[196:197], v8 offset:1920
    ds_read_b64 v[198:199], v8 offset:1928
    ds_read_b64 v[228:229], v8 offset:1408
    ds_read_b64 v[230:231], v8 offset:1416
    ds_read_b64 v[136:137], v8 offset:2880
    ds_read_b64 v[138:139], v8 offset:2888
    ds_read_b64 v[168:169], v8 offset:2368
    ds_read_b64 v[170:171], v8 offset:2376
    ds_read_b64 v[200:201], v8 offset:1856
    ds_read_b64 v[202:203], v8 offset:1864
    ds_read_b64 v[232:233], v8 offset:1344
    ds_read_b64 v[234:235], v8 offset:1352
    ds_read_b64 v[140:141], v8 offset:2816
    ds_read_b64 v[142:143], v8 offset:2824
    ds_read_b64 v[172:173], v8 offset:2304
    ds_read_b64 v[174:175], v8 offset:2312
    ds_read_b64 v[204:205], v8 offset:1792
    ds_read_b64 v[206:207], v8 offset:1800
    ds_read_b64 v[236:237], v8 offset:1280
    ds_read_b64 v[238:239], v8 offset:1288
    ds_read_b64 v[144:145], v8 offset:2752
    ds_read_b64 v[146:147], v8 offset:2760
    ds_read_b64 v[176:177], v8 offset:2240
    ds_read_b64 v[178:179], v8 offset:2248
    ds_read_b64 v[208:209], v8 offset:1728
    ds_read_b64 v[210:211], v8 offset:1736
    ds_read_b64 v[240:241], v8 offset:1216
    ds_read_b64 v[242:243], v8 offset:1224
    ds_read_b64 v[148:149], v8 offset:2688
    ds_read_b64 v[150:151], v8 offset:2696
    ds_read_b64 v[180:181], v8 offset:2176
    ds_read_b64 v[182:183], v8 offset:2184
    ds_read_b64 v[212:213], v8 offset:1664
    ds_read_b64 v[214:215], v8 offset:1672
    ds_read_b64 v[244:245], v8 offset:1152
    ds_read_b64 v[246:247], v8 offset:1160
    ds_read_b64 v[152:153], v8 offset:2624
    ds_read_b64 v[154:155], v8 offset:2632
    ds_read_b64 v[184:185], v8 offset:2112
    ds_read_b64 v[186:187], v8 offset:2120
    ds_read_b64 v[216:217], v8 offset:1600
    ds_read_b64 v[218:219], v8 offset:1608
    ds_read_b64 v[248:249], v8 offset:1088
    ds_read_b64 v[250:251], v8 offset:1096
    ds_read_b64 v[156:157], v8 offset:2560
    ds_read_b64 v[158:159], v8 offset:2568
    ds_read_b64 v[188:189], v8 offset:2048
    ds_read_b64 v[190:191], v8 offset:2056
    ds_read_b64 v[220:221], v8 offset:1536
    ds_read_b64 v[222:223], v8 offset:1544
    ds_read_b64 v[252:253], v8 offset:1024
    ds_read_b64 v[254:255], v8 offset:1032
    s_waitcnt vmcnt(3)
    ds_read_b128 v[16:19], v9 offset:448
    ds_read_b128 v[20:23], v9 offset:384
    ds_read_b128 v[24:27], v9 offset:320
    ds_read_b128 v[28:31], v9 offset:256
    ds_read_b128 v[32:35], v9 offset:192
    s_waitcnt lgkmcnt(3)
    v_mfma_f32_16x16x32_bf16 v[40:43], v[64:67], v[16:19], 0
    ds_read_b128 v[36:39], v9 offset:128
    v_mfma_f32_16x16x32_bf16 v[44:47], v[96:99], v[16:19], 0
    ds_read_b128 v[16:19], v9 offset:64
    v_mfma_f32_16x16x32_bf16 v[40:43], v[68:71], v[20:23], v[40:43]
    v_mfma_f32_16x16x32_bf16 v[44:47], v[100:103], v[20:23], v[44:47]
    ds_read_b128 v[20:23], v9 offset:0
    s_waitcnt lgkmcnt(4)
    v_mfma_f32_16x16x32_bf16 v[40:43], v[72:75], v[24:27], v[40:43]
    v_mfma_f32_16x16x32_bf16 v[44:47], v[104:107], v[24:27], v[44:47]
    ds_read_b128 v[24:27], v9 offset:960
    v_mfma_f32_16x16x32_bf16 v[40:43], v[76:79], v[28:31], v[40:43]
    v_mfma_f32_16x16x32_bf16 v[44:47], v[108:111], v[28:31], v[44:47]
    ds_read_b128 v[28:31], v9 offset:896
    s_waitcnt lgkmcnt(4)
    v_mfma_f32_16x16x32_bf16 v[40:43], v[80:83], v[32:35], v[40:43]
    v_mfma_f32_16x16x32_bf16 v[44:47], v[112:115], v[32:35], v[44:47]
    ds_read_b128 v[32:35], v9 offset:832
    v_mfma_f32_16x16x32_bf16 v[40:43], v[84:87], v[36:39], v[40:43]
    v_mfma_f32_16x16x32_bf16 v[44:47], v[116:119], v[36:39], v[44:47]
    ds_read_b128 v[36:39], v9 offset:768
    s_waitcnt lgkmcnt(4)
    v_mfma_f32_16x16x32_bf16 v[40:43], v[88:91], v[16:19], v[40:43]
    v_mfma_f32_16x16x32_bf16 v[44:47], v[120:123], v[16:19], v[44:47]
    ds_read_b128 v[16:19], v9 offset:704
    v_mfma_f32_16x16x32_bf16 v[40:43], v[92:95], v[20:23], v[40:43]
    v_mfma_f32_16x16x32_bf16 v[44:47], v[124:127], v[20:23], v[44:47]
    ds_read_b128 v[20:23], v9 offset:640
    s_waitcnt lgkmcnt(4)
    v_mfma_f32_16x16x32_bf16 v[44:47], v[64:67], v[24:27], v[44:47]
    v_mfma_f32_16x16x32_bf16 v[48:51], v[96:99], v[24:27], 0
    ds_read_b128 v[24:27], v9 offset:576
    v_mfma_f32_16x16x32_bf16 v[44:47], v[68:71], v[28:31], v[44:47]
    v_mfma_f32_16x16x32_bf16 v[48:51], v[100:103], v[28:31], v[48:51]
    ds_read_b128 v[28:31], v9 offset:512
    s_waitcnt lgkmcnt(4)
    v_mfma_f32_16x16x32_bf16 v[44:47], v[72:75], v[32:35], v[44:47]
    v_mfma_f32_16x16x32_bf16 v[48:51], v[104:107], v[32:35], v[48:51]
    s_waitcnt vmcnt(2)
    ds_read_b128 v[32:35], v9 offset:1472
    v_mfma_f32_16x16x32_bf16 v[44:47], v[76:79], v[36:39], v[44:47]
    v_mfma_f32_16x16x32_bf16 v[48:51], v[108:111], v[36:39], v[48:51]
    ds_read_b128 v[36:39], v9 offset:1408
    v_cvt_pk_bf16_f32 v12, v40, v41
    v_cvt_pk_bf16_f32 v13, v42, v43
    v_mov_b32 v7, 2
    ds_write_b64 v10, v[12:13] offset:0
    ds_write_b32 v11, v7
    s_waitcnt lgkmcnt(6)
    v_mfma_f32_16x16x32_bf16 v[44:47], v[80:83], v[16:19], v[44:47]
    v_mfma_f32_16x16x32_bf16 v[48:51], v[112:115], v[16:19], v[48:51]
    ds_read_b128 v[16:19], v9 offset:1344
    v_mfma_f32_16x16x32_bf16 v[44:47], v[84:87], v[20:23], v[44:47]
    v_mfma_f32_16x16x32_bf16 v[48:51], v[116:119], v[20:23], v[48:51]
    ds_read_b128 v[20:23], v9 offset:1280
    s_waitcnt lgkmcnt(6)
    v_mfma_f32_16x16x32_bf16 v[44:47], v[88:91], v[24:27], v[44:47]
    v_mfma_f32_16x16x32_bf16 v[48:51], v[120:123], v[24:27], v[48:51]
    ds_read_b128 v[24:27], v9 offset:1216
    v_mfma_f32_16x16x32_bf16 v[44:47], v[92:95], v[28:31], v[44:47]
    v_mfma_f32_16x16x32_bf16 v[48:51], v[124:127], v[28:31], v[48:51]
    ds_read_b128 v[28:31], v9 offset:1152
    s_waitcnt lgkmcnt(6)
    v_mfma_f32_16x16x32_bf16 v[48:51], v[64:67], v[32:35], v[48:51]
    v_mfma_f32_16x16x32_bf16 v[52:55], v[96:99], v[32:35], 0
    ds_read_b128 v[32:35], v9 offset:1088
    v_mfma_f32_16x16x32_bf16 v[48:51], v[68:71], v[36:39], v[48:51]
    v_mfma_f32_16x16x32_bf16 v[52:55], v[100:103], v[36:39], v[52:55]
    ds_read_b128 v[36:39], v9 offset:1024
    s_waitcnt lgkmcnt(4)
    v_mfma_f32_16x16x32_bf16 v[48:51], v[72:75], v[16:19], v[48:51]
    v_mfma_f32_16x16x32_bf16 v[52:55], v[104:107], v[16:19], v[52:55]
    ds_read_b128 v[16:19], v9 offset:1984
    v_mfma_f32_16x16x32_bf16 v[48:51], v[76:79], v[20:23], v[48:51]
    v_mfma_f32_16x16x32_bf16 v[52:55], v[108:111], v[20:23], v[52:55]
    ds_read_b128 v[20:23], v9 offset:1920
    v_cvt_pk_bf16_f32 v14, v44, v45
    v_cvt_pk_bf16_f32 v15, v46, v47
    v_mov_b32 v7, 3
    ds_write_b64 v10, v[14:15] offset:512
    ds_write_b32 v11, v7
    s_waitcnt lgkmcnt(6)
    v_mfma_f32_16x16x32_bf16 v[48:51], v[80:83], v[24:27], v[48:51]
    v_mfma_f32_16x16x32_bf16 v[52:55], v[112:115], v[24:27], v[52:55]
    ds_read_b128 v[24:27], v9 offset:1856
    v_mfma_f32_16x16x32_bf16 v[48:51], v[84:87], v[28:31], v[48:51]
    v_mfma_f32_16x16x32_bf16 v[52:55], v[116:119], v[28:31], v[52:55]
    ds_read_b128 v[28:31], v9 offset:1792
    s_waitcnt lgkmcnt(6)
    v_mfma_f32_16x16x32_bf16 v[48:51], v[88:91], v[32:35], v[48:51]
    v_mfma_f32_16x16x32_bf16 v[52:55], v[120:123], v[32:35], v[52:55]
    ds_read_b128 v[32:35], v9 offset:1728
    v_mfma_f32_16x16x32_bf16 v[48:51], v[92:95], v[36:39], v[48:51]
    v_mfma_f32_16x16x32_bf16 v[52:55], v[124:127], v[36:39], v[52:55]
    ds_read_b128 v[36:39], v9 offset:1664
    s_waitcnt lgkmcnt(6)
    v_mfma_f32_16x16x32_bf16 v[52:55], v[64:67], v[16:19], v[52:55]
    ds_read_b128 v[16:19], v9 offset:1600
    v_mfma_f32_16x16x32_bf16 v[52:55], v[68:71], v[20:23], v[52:55]
    ds_read_b128 v[20:23], v9 offset:1536
    s_waitcnt lgkmcnt(4)
    v_mfma_f32_16x16x32_bf16 v[52:55], v[72:75], v[24:27], v[52:55]
    ds_read_b128 v[24:27], v9 offset:960
    v_mfma_f32_16x16x32_bf16 v[52:55], v[76:79], v[28:31], v[52:55]
    ds_read_b128 v[28:31], v9 offset:896
    s_waitcnt lgkmcnt(4)
    v_mfma_f32_16x16x32_bf16 v[52:55], v[80:83], v[32:35], v[52:55]
    ds_read_b128 v[32:35], v9 offset:832
    v_mfma_f32_16x16x32_bf16 v[52:55], v[84:87], v[36:39], v[52:55]
    ds_read_b128 v[36:39], v9 offset:768
    s_waitcnt lgkmcnt(4)
    v_mfma_f32_16x16x32_bf16 v[52:55], v[88:91], v[16:19], v[52:55]
    ds_read_b128 v[16:19], v9 offset:704
    v_mfma_f32_16x16x32_bf16 v[52:55], v[92:95], v[20:23], v[52:55]
    ds_read_b128 v[20:23], v9 offset:640
    s_waitcnt lgkmcnt(4)
    v_mfma_f32_16x16x32_bf16 v[52:55], v[128:131], v[24:27], v[52:55]
    ds_read_b128 v[24:27], v9 offset:576
    v_mfma_f32_16x16x32_bf16 v[52:55], v[132:135], v[28:31], v[52:55]
    ds_read_b128 v[28:31], v9 offset:512
    s_waitcnt lgkmcnt(4)
    v_mfma_f32_16x16x32_bf16 v[52:55], v[136:139], v[32:35], v[52:55]
    ds_read_b128 v[32:35], v9 offset:448
    v_mfma_f32_16x16x32_bf16 v[52:55], v[140:143], v[36:39], v[52:55]
    ds_read_b128 v[36:39], v9 offset:384
    s_waitcnt lgkmcnt(4)
    v_mfma_f32_16x16x32_bf16 v[52:55], v[144:147], v[16:19], v[52:55]
    ds_read_b128 v[16:19], v9 offset:320
    v_mfma_f32_16x16x32_bf16 v[52:55], v[148:151], v[20:23], v[52:55]
    ds_read_b128 v[20:23], v9 offset:256
    s_waitcnt lgkmcnt(4)
    v_mfma_f32_16x16x32_bf16 v[52:55], v[152:155], v[24:27], v[52:55]
    ds_read_b128 v[24:27], v9 offset:192
    v_mfma_f32_16x16x32_bf16 v[52:55], v[156:159], v[28:31], v[52:55]
    ds_read_b128 v[28:31], v9 offset:128
    s_waitcnt lgkmcnt(4)
    v_mfma_f32_16x16x32_bf16 v[48:51], v[128:131], v[32:35], v[48:51]
    v_mfma_f32_16x16x32_bf16 v[52:55], v[160:163], v[32:35], v[52:55]
    ds_read_b128 v[32:35], v9 offset:64
    v_mfma_f32_16x16x32_bf16 v[48:51], v[132:135], v[36:39], v[48:51]
    v_mfma_f32_16x16x32_bf16 v[52:55], v[164:167], v[36:39], v[52:55]
    ds_read_b128 v[36:39], v9 offset:0
    s_waitcnt lgkmcnt(4)
    v_mfma_f32_16x16x32_bf16 v[48:51], v[136:139], v[16:19], v[48:51]
    v_mfma_f32_16x16x32_bf16 v[52:55], v[168:171], v[16:19], v[52:55]
    s_waitcnt vmcnt(1)
    ds_read_b128 v[16:19], v9 offset:3008
    v_mfma_f32_16x16x32_bf16 v[48:51], v[140:143], v[20:23], v[48:51]
    v_mfma_f32_16x16x32_bf16 v[52:55], v[172:175], v[20:23], v[52:55]
    ds_read_b128 v[20:23], v9 offset:2944
    s_waitcnt lgkmcnt(4)
    v_mfma_f32_16x16x32_bf16 v[48:51], v[144:147], v[24:27], v[48:51]
    v_mfma_f32_16x16x32_bf16 v[52:55], v[176:179], v[24:27], v[52:55]
    ds_read_b128 v[24:27], v9 offset:2880
    v_mfma_f32_16x16x32_bf16 v[48:51], v[148:151], v[28:31], v[48:51]
    v_mfma_f32_16x16x32_bf16 v[52:55], v[180:183], v[28:31], v[52:55]
    ds_read_b128 v[28:31], v9 offset:2816
    s_waitcnt lgkmcnt(4)
    v_mfma_f32_16x16x32_bf16 v[48:51], v[152:155], v[32:35], v[48:51]
    v_mfma_f32_16x16x32_bf16 v[52:55], v[184:187], v[32:35], v[52:55]
    ds_read_b128 v[32:35], v9 offset:2752
    v_mfma_f32_16x16x32_bf16 v[48:51], v[156:159], v[36:39], v[48:51]
    v_mfma_f32_16x16x32_bf16 v[52:55], v[188:191], v[36:39], v[52:55]
    ds_read_b128 v[36:39], v9 offset:2688
    s_waitcnt lgkmcnt(4)
    v_mfma_f32_16x16x32_bf16 v[60:63], v[64:67], v[16:19], 0
    ds_read_b128 v[16:19], v9 offset:2624
    v_mfma_f32_16x16x32_bf16 v[60:63], v[68:71], v[20:23], v[60:63]
    ds_read_b128 v[20:23], v9 offset:2560
    s_waitcnt lgkmcnt(4)
    v_mfma_f32_16x16x32_bf16 v[60:63], v[72:75], v[24:27], v[60:63]
    ds_read_b128 v[24:27], v9 offset:2496
    v_mfma_f32_16x16x32_bf16 v[60:63], v[76:79], v[28:31], v[60:63]
    ds_read_b128 v[28:31], v9 offset:2432
    s_waitcnt lgkmcnt(4)
    v_mfma_f32_16x16x32_bf16 v[60:63], v[80:83], v[32:35], v[60:63]
    ds_read_b128 v[32:35], v9 offset:2368
    v_mfma_f32_16x16x32_bf16 v[60:63], v[84:87], v[36:39], v[60:63]
    ds_read_b128 v[36:39], v9 offset:2304
    s_waitcnt lgkmcnt(4)
    v_mfma_f32_16x16x32_bf16 v[60:63], v[88:91], v[16:19], v[60:63]
    ds_read_b128 v[16:19], v9 offset:2240
    v_mfma_f32_16x16x32_bf16 v[60:63], v[92:95], v[20:23], v[60:63]
    ds_read_b128 v[20:23], v9 offset:2176
    v_cvt_pk_bf16_f32 v12, v48, v49
    v_cvt_pk_bf16_f32 v13, v50, v51
    ds_write_b64 v10, v[12:13] offset:1024
    s_waitcnt lgkmcnt(5)
    v_mfma_f32_16x16x32_bf16 v[56:59], v[64:67], v[24:27], 0
    v_cvt_pk_bf16_f32 v14, v52, v53
    v_cvt_pk_bf16_f32 v15, v54, v55
    v_mov_b32 v7, 4
    ds_write_b64 v10, v[14:15] offset:1536
    ds_write_b32 v11, v7
    v_mfma_f32_16x16x32_bf16 v[60:63], v[96:99], v[24:27], v[60:63]
    ds_read_b128 v[24:27], v9 offset:2112
    v_mfma_f32_16x16x32_bf16 v[56:59], v[68:71], v[28:31], v[56:59]
    v_mfma_f32_16x16x32_bf16 v[60:63], v[100:103], v[28:31], v[60:63]
    ds_read_b128 v[28:31], v9 offset:2048
    s_waitcnt lgkmcnt(7)
    v_mfma_f32_16x16x32_bf16 v[56:59], v[72:75], v[32:35], v[56:59]
    v_mfma_f32_16x16x32_bf16 v[60:63], v[104:107], v[32:35], v[60:63]
    ds_read_b128 v[32:35], v9 offset:1984
    v_mfma_f32_16x16x32_bf16 v[56:59], v[76:79], v[36:39], v[56:59]
    v_mfma_f32_16x16x32_bf16 v[60:63], v[108:111], v[36:39], v[60:63]
    ds_read_b128 v[36:39], v9 offset:1920
    s_waitcnt lgkmcnt(7)
    v_mfma_f32_16x16x32_bf16 v[56:59], v[80:83], v[16:19], v[56:59]
    v_mfma_f32_16x16x32_bf16 v[60:63], v[112:115], v[16:19], v[60:63]
    ds_read_b128 v[16:19], v9 offset:1856
    v_mfma_f32_16x16x32_bf16 v[56:59], v[84:87], v[20:23], v[56:59]
    v_mfma_f32_16x16x32_bf16 v[60:63], v[116:119], v[20:23], v[60:63]
    ds_read_b128 v[20:23], v9 offset:1792
    s_waitcnt lgkmcnt(4)
    v_mfma_f32_16x16x32_bf16 v[56:59], v[88:91], v[24:27], v[56:59]
    v_mfma_f32_16x16x32_bf16 v[60:63], v[120:123], v[24:27], v[60:63]
    ds_read_b128 v[24:27], v9 offset:1728
    v_mfma_f32_16x16x32_bf16 v[56:59], v[92:95], v[28:31], v[56:59]
    v_mfma_f32_16x16x32_bf16 v[60:63], v[124:127], v[28:31], v[60:63]
    ds_read_b128 v[28:31], v9 offset:1664
    s_waitcnt lgkmcnt(4)
    v_mfma_f32_16x16x32_bf16 v[56:59], v[96:99], v[32:35], v[56:59]
    v_mfma_f32_16x16x32_bf16 v[60:63], v[128:131], v[32:35], v[60:63]
    ds_read_b128 v[32:35], v9 offset:1600
    v_mfma_f32_16x16x32_bf16 v[56:59], v[100:103], v[36:39], v[56:59]
    v_mfma_f32_16x16x32_bf16 v[60:63], v[132:135], v[36:39], v[60:63]
    ds_read_b128 v[36:39], v9 offset:1536
    s_waitcnt lgkmcnt(4)
    v_mfma_f32_16x16x32_bf16 v[56:59], v[104:107], v[16:19], v[56:59]
    v_mfma_f32_16x16x32_bf16 v[60:63], v[136:139], v[16:19], v[60:63]
    ds_read_b128 v[16:19], v9 offset:1472
    v_mfma_f32_16x16x32_bf16 v[56:59], v[108:111], v[20:23], v[56:59]
    v_mfma_f32_16x16x32_bf16 v[60:63], v[140:143], v[20:23], v[60:63]
    ds_read_b128 v[20:23], v9 offset:1408
    s_waitcnt lgkmcnt(4)
    v_mfma_f32_16x16x32_bf16 v[56:59], v[112:115], v[24:27], v[56:59]
    v_mfma_f32_16x16x32_bf16 v[60:63], v[144:147], v[24:27], v[60:63]
    ds_read_b128 v[24:27], v9 offset:1344
    v_mfma_f32_16x16x32_bf16 v[56:59], v[116:119], v[28:31], v[56:59]
    v_mfma_f32_16x16x32_bf16 v[60:63], v[148:151], v[28:31], v[60:63]
    ds_read_b128 v[28:31], v9 offset:1280
    s_waitcnt lgkmcnt(4)
    v_mfma_f32_16x16x32_bf16 v[56:59], v[120:123], v[32:35], v[56:59]
    v_mfma_f32_16x16x32_bf16 v[60:63], v[152:155], v[32:35], v[60:63]
    ds_read_b128 v[32:35], v9 offset:1216
    v_mfma_f32_16x16x32_bf16 v[56:59], v[124:127], v[36:39], v[56:59]
    v_mfma_f32_16x16x32_bf16 v[60:63], v[156:159], v[36:39], v[60:63]
    ds_read_b128 v[36:39], v9 offset:1152
    s_waitcnt lgkmcnt(4)
    v_mfma_f32_16x16x32_bf16 v[56:59], v[128:131], v[16:19], v[56:59]
    v_mfma_f32_16x16x32_bf16 v[60:63], v[160:163], v[16:19], v[60:63]
    ds_read_b128 v[16:19], v9 offset:1088
    v_mfma_f32_16x16x32_bf16 v[56:59], v[132:135], v[20:23], v[56:59]
    v_mfma_f32_16x16x32_bf16 v[60:63], v[164:167], v[20:23], v[60:63]
    ds_read_b128 v[20:23], v9 offset:1024
    s_waitcnt lgkmcnt(4)
    v_mfma_f32_16x16x32_bf16 v[56:59], v[136:139], v[24:27], v[56:59]
    v_mfma_f32_16x16x32_bf16 v[60:63], v[168:171], v[24:27], v[60:63]
    ds_read_b128 v[24:27], v9 offset:960
    v_mfma_f32_16x16x32_bf16 v[56:59], v[140:143], v[28:31], v[56:59]
    v_mfma_f32_16x16x32_bf16 v[60:63], v[172:175], v[28:31], v[60:63]
    ds_read_b128 v[28:31], v9 offset:896
    s_waitcnt lgkmcnt(4)
    v_mfma_f32_16x16x32_bf16 v[56:59], v[144:147], v[32:35], v[56:59]
    v_mfma_f32_16x16x32_bf16 v[60:63], v[176:179], v[32:35], v[60:63]
    ds_read_b128 v[32:35], v9 offset:832
    v_mfma_f32_16x16x32_bf16 v[56:59], v[148:151], v[36:39], v[56:59]
    v_mfma_f32_16x16x32_bf16 v[60:63], v[180:183], v[36:39], v[60:63]
    ds_read_b128 v[36:39], v9 offset:768
    s_waitcnt lgkmcnt(4)
    v_mfma_f32_16x16x32_bf16 v[56:59], v[152:155], v[16:19], v[56:59]
    v_mfma_f32_16x16x32_bf16 v[60:63], v[184:187], v[16:19], v[60:63]
    ds_read_b128 v[16:19], v9 offset:704
    v_mfma_f32_16x16x32_bf16 v[56:59], v[156:159], v[20:23], v[56:59]
    v_mfma_f32_16x16x32_bf16 v[60:63], v[188:191], v[20:23], v[60:63]
    ds_read_b128 v[20:23], v9 offset:640
    s_waitcnt lgkmcnt(4)
    v_mfma_f32_16x16x32_bf16 v[56:59], v[160:163], v[24:27], v[56:59]
    v_mfma_f32_16x16x32_bf16 v[60:63], v[192:195], v[24:27], v[60:63]
    ds_read_b128 v[24:27], v9 offset:576
    v_mfma_f32_16x16x32_bf16 v[56:59], v[164:167], v[28:31], v[56:59]
    v_mfma_f32_16x16x32_bf16 v[60:63], v[196:199], v[28:31], v[60:63]
    ds_read_b128 v[28:31], v9 offset:512
    s_waitcnt lgkmcnt(4)
    v_mfma_f32_16x16x32_bf16 v[56:59], v[168:171], v[32:35], v[56:59]
    v_mfma_f32_16x16x32_bf16 v[60:63], v[200:203], v[32:35], v[60:63]
    ds_read_b128 v[32:35], v9 offset:448
    v_mfma_f32_16x16x32_bf16 v[56:59], v[172:175], v[36:39], v[56:59]
    v_mfma_f32_16x16x32_bf16 v[60:63], v[204:207], v[36:39], v[60:63]
    ds_read_b128 v[36:39], v9 offset:384
    s_waitcnt lgkmcnt(4)
    v_mfma_f32_16x16x32_bf16 v[56:59], v[176:179], v[16:19], v[56:59]
    v_mfma_f32_16x16x32_bf16 v[60:63], v[208:211], v[16:19], v[60:63]
    ds_read_b128 v[16:19], v9 offset:320
    v_mfma_f32_16x16x32_bf16 v[56:59], v[180:183], v[20:23], v[56:59]
    v_mfma_f32_16x16x32_bf16 v[60:63], v[212:215], v[20:23], v[60:63]
    ds_read_b128 v[20:23], v9 offset:256
    s_waitcnt lgkmcnt(4)
    v_mfma_f32_16x16x32_bf16 v[56:59], v[184:187], v[24:27], v[56:59]
    v_mfma_f32_16x16x32_bf16 v[60:63], v[216:219], v[24:27], v[60:63]
    ds_read_b128 v[24:27], v9 offset:192
    v_mfma_f32_16x16x32_bf16 v[56:59], v[188:191], v[28:31], v[56:59]
    v_mfma_f32_16x16x32_bf16 v[60:63], v[220:223], v[28:31], v[60:63]
    ds_read_b128 v[28:31], v9 offset:128
    s_waitcnt lgkmcnt(4)
    v_mfma_f32_16x16x32_bf16 v[56:59], v[192:195], v[32:35], v[56:59]
    v_mfma_f32_16x16x32_bf16 v[60:63], v[224:227], v[32:35], v[60:63]
    ds_read_b128 v[32:35], v9 offset:64
    v_mfma_f32_16x16x32_bf16 v[56:59], v[196:199], v[36:39], v[56:59]
    v_mfma_f32_16x16x32_bf16 v[60:63], v[228:231], v[36:39], v[60:63]
    ds_read_b128 v[36:39], v9 offset:0
    s_waitcnt lgkmcnt(4)
    v_mfma_f32_16x16x32_bf16 v[56:59], v[200:203], v[16:19], v[56:59]
    v_mfma_f32_16x16x32_bf16 v[60:63], v[232:235], v[16:19], v[60:63]
    s_waitcnt vmcnt(0)
    ds_read_b128 v[16:19], v9 offset:3520
    v_mfma_f32_16x16x32_bf16 v[56:59], v[204:207], v[20:23], v[56:59]
    v_mfma_f32_16x16x32_bf16 v[60:63], v[236:239], v[20:23], v[60:63]
    ds_read_b128 v[20:23], v9 offset:3456
    s_waitcnt lgkmcnt(4)
    v_mfma_f32_16x16x32_bf16 v[56:59], v[208:211], v[24:27], v[56:59]
    v_mfma_f32_16x16x32_bf16 v[60:63], v[240:243], v[24:27], v[60:63]
    ds_read_b128 v[24:27], v9 offset:3392
    v_mfma_f32_16x16x32_bf16 v[56:59], v[212:215], v[28:31], v[56:59]
    v_mfma_f32_16x16x32_bf16 v[60:63], v[244:247], v[28:31], v[60:63]
    ds_read_b128 v[28:31], v9 offset:3328
    s_waitcnt lgkmcnt(4)
    v_mfma_f32_16x16x32_bf16 v[56:59], v[216:219], v[32:35], v[56:59]
    v_mfma_f32_16x16x32_bf16 v[60:63], v[248:251], v[32:35], v[60:63]
    ds_read_b128 v[32:35], v9 offset:3264
    v_mfma_f32_16x16x32_bf16 v[56:59], v[220:223], v[36:39], v[56:59]
    v_mfma_f32_16x16x32_bf16 v[60:63], v[252:255], v[36:39], v[60:63]
    ds_read_b128 v[36:39], v9 offset:3200
    s_waitcnt lgkmcnt(4)
    v_mfma_f32_16x16x32_bf16 v[40:43], v[64:67], v[16:19], 0
    v_mfma_f32_16x16x32_bf16 v[44:47], v[96:99], v[16:19], 0
    ds_read_b128 v[16:19], v9 offset:3136
    v_mfma_f32_16x16x32_bf16 v[40:43], v[68:71], v[20:23], v[40:43]
    v_mfma_f32_16x16x32_bf16 v[44:47], v[100:103], v[20:23], v[44:47]
    ds_read_b128 v[20:23], v9 offset:3072
    s_waitcnt lgkmcnt(4)
    v_mfma_f32_16x16x32_bf16 v[40:43], v[72:75], v[24:27], v[40:43]
    v_mfma_f32_16x16x32_bf16 v[44:47], v[104:107], v[24:27], v[44:47]
    ds_read_b128 v[24:27], v9 offset:3008
    v_mfma_f32_16x16x32_bf16 v[40:43], v[76:79], v[28:31], v[40:43]
    v_mfma_f32_16x16x32_bf16 v[44:47], v[108:111], v[28:31], v[44:47]
    ds_read_b128 v[28:31], v9 offset:2944
    v_cvt_pk_bf16_f32 v12, v56, v57
    v_cvt_pk_bf16_f32 v13, v58, v59
    ds_write_b64 v10, v[12:13] offset:2048
    s_waitcnt lgkmcnt(5)
    v_mfma_f32_16x16x32_bf16 v[40:43], v[80:83], v[32:35], v[40:43]
    v_cvt_pk_bf16_f32 v14, v60, v61
    v_cvt_pk_bf16_f32 v15, v62, v63
    v_mov_b32 v7, 5
    ds_write_b64 v10, v[14:15] offset:2560
    ds_write_b32 v11, v7
    v_mfma_f32_16x16x32_bf16 v[44:47], v[112:115], v[32:35], v[44:47]
    ds_read_b128 v[32:35], v9 offset:2880
    v_mfma_f32_16x16x32_bf16 v[40:43], v[84:87], v[36:39], v[40:43]
    v_mfma_f32_16x16x32_bf16 v[44:47], v[116:119], v[36:39], v[44:47]
    ds_read_b128 v[36:39], v9 offset:2816
    s_waitcnt lgkmcnt(7)
    v_mfma_f32_16x16x32_bf16 v[40:43], v[88:91], v[16:19], v[40:43]
    v_mfma_f32_16x16x32_bf16 v[44:47], v[120:123], v[16:19], v[44:47]
    ds_read_b128 v[16:19], v9 offset:2752
    v_mfma_f32_16x16x32_bf16 v[40:43], v[92:95], v[20:23], v[40:43]
    v_mfma_f32_16x16x32_bf16 v[44:47], v[124:127], v[20:23], v[44:47]
    ds_read_b128 v[20:23], v9 offset:2688
    s_waitcnt lgkmcnt(7)
    v_mfma_f32_16x16x32_bf16 v[40:43], v[96:99], v[24:27], v[40:43]
    ds_read_b64 v[96:97], v8 offset:960
    v_mfma_f32_16x16x32_bf16 v[44:47], v[128:131], v[24:27], v[44:47]
    ds_read_b128 v[24:27], v9 offset:2624
    v_mfma_f32_16x16x32_bf16 v[40:43], v[100:103], v[28:31], v[40:43]
    ds_read_b64 v[98:99], v8 offset:968
    v_mfma_f32_16x16x32_bf16 v[44:47], v[132:135], v[28:31], v[44:47]
    ds_read_b128 v[28:31], v9 offset:2560
    s_waitcnt lgkmcnt(6)
    v_mfma_f32_16x16x32_bf16 v[40:43], v[104:107], v[32:35], v[40:43]
    ds_read_b64 v[100:101], v8 offset:896
    v_mfma_f32_16x16x32_bf16 v[44:47], v[136:139], v[32:35], v[44:47]
    ds_read_b128 v[32:35], v9 offset:2496
    v_mfma_f32_16x16x32_bf16 v[40:43], v[108:111], v[36:39], v[40:43]
    ds_read_b64 v[102:103], v8 offset:904
    v_mfma_f32_16x16x32_bf16 v[44:47], v[140:143], v[36:39], v[44:47]
    ds_read_b128 v[36:39], v9 offset:2432
    s_waitcnt lgkmcnt(8)
    v_mfma_f32_16x16x32_bf16 v[40:43], v[112:115], v[16:19], v[40:43]
    ds_read_b64 v[104:105], v8 offset:832
    v_mfma_f32_16x16x32_bf16 v[44:47], v[144:147], v[16:19], v[44:47]
    ds_read_b128 v[16:19], v9 offset:2368
    v_mfma_f32_16x16x32_bf16 v[40:43], v[116:119], v[20:23], v[40:43]
    ds_read_b64 v[106:107], v8 offset:840
    v_mfma_f32_16x16x32_bf16 v[44:47], v[148:151], v[20:23], v[44:47]
    ds_read_b128 v[20:23], v9 offset:2304
    s_waitcnt lgkmcnt(8)
    v_mfma_f32_16x16x32_bf16 v[40:43], v[120:123], v[24:27], v[40:43]
    ds_read_b64 v[108:109], v8 offset:768
    v_mfma_f32_16x16x32_bf16 v[44:47], v[152:155], v[24:27], v[44:47]
    ds_read_b128 v[24:27], v9 offset:2240
    v_mfma_f32_16x16x32_bf16 v[40:43], v[124:127], v[28:31], v[40:43]
    ds_read_b64 v[110:111], v8 offset:776
    v_mfma_f32_16x16x32_bf16 v[44:47], v[156:159], v[28:31], v[44:47]
    ds_read_b128 v[28:31], v9 offset:2176
    s_waitcnt lgkmcnt(8)
    v_mfma_f32_16x16x32_bf16 v[40:43], v[128:131], v[32:35], v[40:43]
    ds_read_b64 v[112:113], v8 offset:704
    v_mfma_f32_16x16x32_bf16 v[44:47], v[160:163], v[32:35], v[44:47]
    ds_read_b128 v[32:35], v9 offset:2112
    v_mfma_f32_16x16x32_bf16 v[40:43], v[132:135], v[36:39], v[40:43]
    ds_read_b64 v[114:115], v8 offset:712
    v_mfma_f32_16x16x32_bf16 v[44:47], v[164:167], v[36:39], v[44:47]
    ds_read_b128 v[36:39], v9 offset:2048
    s_waitcnt lgkmcnt(8)
    v_mfma_f32_16x16x32_bf16 v[40:43], v[136:139], v[16:19], v[40:43]
    ds_read_b64 v[116:117], v8 offset:640
    v_mfma_f32_16x16x32_bf16 v[44:47], v[168:171], v[16:19], v[44:47]
    ds_read_b128 v[16:19], v9 offset:1984
    v_mfma_f32_16x16x32_bf16 v[40:43], v[140:143], v[20:23], v[40:43]
    ds_read_b64 v[118:119], v8 offset:648
    v_mfma_f32_16x16x32_bf16 v[44:47], v[172:175], v[20:23], v[44:47]
    ds_read_b128 v[20:23], v9 offset:1920
    s_waitcnt lgkmcnt(8)
    v_mfma_f32_16x16x32_bf16 v[40:43], v[144:147], v[24:27], v[40:43]
    ds_read_b64 v[120:121], v8 offset:576
    v_mfma_f32_16x16x32_bf16 v[44:47], v[176:179], v[24:27], v[44:47]
    ds_read_b128 v[24:27], v9 offset:1856
    v_mfma_f32_16x16x32_bf16 v[40:43], v[148:151], v[28:31], v[40:43]
    ds_read_b64 v[122:123], v8 offset:584
    v_mfma_f32_16x16x32_bf16 v[44:47], v[180:183], v[28:31], v[44:47]
    ds_read_b128 v[28:31], v9 offset:1792
    s_waitcnt lgkmcnt(8)
    v_mfma_f32_16x16x32_bf16 v[40:43], v[152:155], v[32:35], v[40:43]
    ds_read_b64 v[124:125], v8 offset:512
    v_mfma_f32_16x16x32_bf16 v[44:47], v[184:187], v[32:35], v[44:47]
    ds_read_b128 v[32:35], v9 offset:1728
    v_mfma_f32_16x16x32_bf16 v[40:43], v[156:159], v[36:39], v[40:43]
    ds_read_b64 v[126:127], v8 offset:520
    v_mfma_f32_16x16x32_bf16 v[44:47], v[188:191], v[36:39], v[44:47]
    ds_read_b128 v[36:39], v9 offset:1664
    s_waitcnt lgkmcnt(8)
    v_mfma_f32_16x16x32_bf16 v[40:43], v[160:163], v[16:19], v[40:43]
    ds_read_b64 v[128:129], v8 offset:448
    v_mfma_f32_16x16x32_bf16 v[44:47], v[192:195], v[16:19], v[44:47]
    ds_read_b128 v[16:19], v9 offset:1600
    v_mfma_f32_16x16x32_bf16 v[40:43], v[164:167], v[20:23], v[40:43]
    ds_read_b64 v[130:131], v8 offset:456
    v_mfma_f32_16x16x32_bf16 v[44:47], v[196:199], v[20:23], v[44:47]
    ds_read_b128 v[20:23], v9 offset:1536
    s_waitcnt lgkmcnt(8)
    v_mfma_f32_16x16x32_bf16 v[40:43], v[168:171], v[24:27], v[40:43]
    ds_read_b64 v[132:133], v8 offset:384
    v_mfma_f32_16x16x32_bf16 v[44:47], v[200:203], v[24:27], v[44:47]
    ds_read_b128 v[24:27], v9 offset:1472
    v_mfma_f32_16x16x32_bf16 v[40:43], v[172:175], v[28:31], v[40:43]
    ds_read_b64 v[134:135], v8 offset:392
    v_mfma_f32_16x16x32_bf16 v[44:47], v[204:207], v[28:31], v[44:47]
    ds_read_b128 v[28:31], v9 offset:1408
    s_waitcnt lgkmcnt(8)
    v_mfma_f32_16x16x32_bf16 v[40:43], v[176:179], v[32:35], v[40:43]
    ds_read_b64 v[136:137], v8 offset:320
    v_mfma_f32_16x16x32_bf16 v[44:47], v[208:211], v[32:35], v[44:47]
    ds_read_b128 v[32:35], v9 offset:1344
    v_mfma_f32_16x16x32_bf16 v[40:43], v[180:183], v[36:39], v[40:43]
    ds_read_b64 v[138:139], v8 offset:328
    v_mfma_f32_16x16x32_bf16 v[44:47], v[212:215], v[36:39], v[44:47]
    ds_read_b128 v[36:39], v9 offset:1280
    s_waitcnt lgkmcnt(8)
    v_mfma_f32_16x16x32_bf16 v[40:43], v[184:187], v[16:19], v[40:43]
    ds_read_b64 v[140:141], v8 offset:256
    v_mfma_f32_16x16x32_bf16 v[44:47], v[216:219], v[16:19], v[44:47]
    ds_read_b128 v[16:19], v9 offset:1216
    v_mfma_f32_16x16x32_bf16 v[40:43], v[188:191], v[20:23], v[40:43]
    ds_read_b64 v[142:143], v8 offset:264
    v_mfma_f32_16x16x32_bf16 v[44:47], v[220:223], v[20:23], v[44:47]
    ds_read_b128 v[20:23], v9 offset:1152
    s_waitcnt lgkmcnt(8)
    v_mfma_f32_16x16x32_bf16 v[40:43], v[192:195], v[24:27], v[40:43]
    ds_read_b64 v[144:145], v8 offset:192
    v_mfma_f32_16x16x32_bf16 v[44:47], v[224:227], v[24:27], v[44:47]
    ds_read_b128 v[24:27], v9 offset:1088
    v_mfma_f32_16x16x32_bf16 v[40:43], v[196:199], v[28:31], v[40:43]
    ds_read_b64 v[146:147], v8 offset:200
    v_mfma_f32_16x16x32_bf16 v[44:47], v[228:231], v[28:31], v[44:47]
    ds_read_b128 v[28:31], v9 offset:1024
    s_waitcnt lgkmcnt(8)
    v_mfma_f32_16x16x32_bf16 v[40:43], v[200:203], v[32:35], v[40:43]
    ds_read_b64 v[148:149], v8 offset:128
    v_mfma_f32_16x16x32_bf16 v[44:47], v[232:235], v[32:35], v[44:47]
    ds_read_b128 v[32:35], v9 offset:960
    v_mfma_f32_16x16x32_bf16 v[40:43], v[204:207], v[36:39], v[40:43]
    ds_read_b64 v[150:151], v8 offset:136
    v_mfma_f32_16x16x32_bf16 v[44:47], v[236:239], v[36:39], v[44:47]
    ds_read_b128 v[36:39], v9 offset:896
    s_waitcnt lgkmcnt(8)
    v_mfma_f32_16x16x32_bf16 v[40:43], v[208:211], v[16:19], v[40:43]
    ds_read_b64 v[152:153], v8 offset:64
    v_mfma_f32_16x16x32_bf16 v[44:47], v[240:243], v[16:19], v[44:47]
    ds_read_b128 v[16:19], v9 offset:832
    v_mfma_f32_16x16x32_bf16 v[40:43], v[212:215], v[20:23], v[40:43]
    ds_read_b64 v[154:155], v8 offset:72
    v_mfma_f32_16x16x32_bf16 v[44:47], v[244:247], v[20:23], v[44:47]
    ds_read_b128 v[20:23], v9 offset:768
    s_waitcnt lgkmcnt(8)
    v_mfma_f32_16x16x32_bf16 v[40:43], v[216:219], v[24:27], v[40:43]
    ds_read_b64 v[156:157], v8 offset:0
    v_mfma_f32_16x16x32_bf16 v[44:47], v[248:251], v[24:27], v[44:47]
    ds_read_b128 v[24:27], v9 offset:704
    v_mfma_f32_16x16x32_bf16 v[40:43], v[220:223], v[28:31], v[40:43]
    ds_read_b64 v[158:159], v8 offset:8
    v_mfma_f32_16x16x32_bf16 v[44:47], v[252:255], v[28:31], v[44:47]
    ds_read_b128 v[28:31], v9 offset:640
    s_waitcnt lgkmcnt(8)
    v_mfma_f32_16x16x32_bf16 v[40:43], v[224:227], v[32:35], v[40:43]
    ds_read_b128 v[32:35], v9 offset:576
    v_mfma_f32_16x16x32_bf16 v[40:43], v[228:231], v[36:39], v[40:43]
    ds_read_b128 v[36:39], v9 offset:512
    s_waitcnt lgkmcnt(6)
    v_mfma_f32_16x16x32_bf16 v[40:43], v[232:235], v[16:19], v[40:43]
    ds_read_b128 v[16:19], v9 offset:448
    v_mfma_f32_16x16x32_bf16 v[40:43], v[236:239], v[20:23], v[40:43]
    ds_read_b128 v[20:23], v9 offset:384
    s_waitcnt lgkmcnt(4)
    v_mfma_f32_16x16x32_bf16 v[40:43], v[240:243], v[24:27], v[40:43]
    ds_read_b128 v[24:27], v9 offset:320
    v_mfma_f32_16x16x32_bf16 v[40:43], v[244:247], v[28:31], v[40:43]
    ds_read_b128 v[28:31], v9 offset:256
    s_waitcnt lgkmcnt(4)
    v_mfma_f32_16x16x32_bf16 v[40:43], v[248:251], v[32:35], v[40:43]
    ds_read_b128 v[32:35], v9 offset:192
    v_mfma_f32_16x16x32_bf16 v[40:43], v[252:255], v[36:39], v[40:43]
    ds_read_b128 v[36:39], v9 offset:128
    s_waitcnt lgkmcnt(4)
    v_mfma_f32_16x16x32_bf16 v[40:43], v[96:99], v[16:19], v[40:43]
    ds_read_b128 v[16:19], v9 offset:64
    v_mfma_f32_16x16x32_bf16 v[40:43], v[100:103], v[20:23], v[40:43]
    ds_read_b128 v[20:23], v9 offset:0
    s_waitcnt lgkmcnt(4)
    v_mfma_f32_16x16x32_bf16 v[40:43], v[104:107], v[24:27], v[40:43]
    ds_read_b128 v[24:27], v9 offset:960
    v_mfma_f32_16x16x32_bf16 v[40:43], v[108:111], v[28:31], v[40:43]
    ds_read_b128 v[28:31], v9 offset:896
    s_waitcnt lgkmcnt(4)
    v_mfma_f32_16x16x32_bf16 v[40:43], v[112:115], v[32:35], v[40:43]
    ds_read_b128 v[32:35], v9 offset:832
    v_mfma_f32_16x16x32_bf16 v[40:43], v[116:119], v[36:39], v[40:43]
    ds_read_b128 v[36:39], v9 offset:768
    s_waitcnt lgkmcnt(4)
    v_mfma_f32_16x16x32_bf16 v[40:43], v[120:123], v[16:19], v[40:43]
    ds_read_b128 v[16:19], v9 offset:704
    v_mfma_f32_16x16x32_bf16 v[40:43], v[124:127], v[20:23], v[40:43]
    ds_read_b128 v[20:23], v9 offset:640
    s_waitcnt lgkmcnt(4)
    v_mfma_f32_16x16x32_bf16 v[44:47], v[96:99], v[24:27], v[44:47]
    ds_read_b128 v[24:27], v9 offset:576
    v_mfma_f32_16x16x32_bf16 v[44:47], v[100:103], v[28:31], v[44:47]
    ds_read_b128 v[28:31], v9 offset:512
    s_waitcnt lgkmcnt(4)
    v_mfma_f32_16x16x32_bf16 v[44:47], v[104:107], v[32:35], v[44:47]
    ds_read_b128 v[32:35], v9 offset:448
    v_mfma_f32_16x16x32_bf16 v[44:47], v[108:111], v[36:39], v[44:47]
    ds_read_b128 v[36:39], v9 offset:384
    s_waitcnt lgkmcnt(4)
    v_mfma_f32_16x16x32_bf16 v[44:47], v[112:115], v[16:19], v[44:47]
    ds_read_b128 v[16:19], v9 offset:320
    v_mfma_f32_16x16x32_bf16 v[44:47], v[116:119], v[20:23], v[44:47]
    ds_read_b128 v[20:23], v9 offset:256
    s_waitcnt lgkmcnt(4)
    v_mfma_f32_16x16x32_bf16 v[44:47], v[120:123], v[24:27], v[44:47]
    ds_read_b128 v[24:27], v9 offset:192
    v_mfma_f32_16x16x32_bf16 v[44:47], v[124:127], v[28:31], v[44:47]
    ds_read_b128 v[28:31], v9 offset:128
    s_waitcnt lgkmcnt(4)
    v_mfma_f32_16x16x32_bf16 v[44:47], v[128:131], v[32:35], v[44:47]
    ds_read_b128 v[32:35], v9 offset:64
    v_cvt_pk_bf16_f32 v12, v40, v41
    v_cvt_pk_bf16_f32 v13, v42, v43
    v_mov_b32 v7, 6
    ds_write_b64 v10, v[12:13] offset:3072
    ds_write_b32 v11, v7
    v_mfma_f32_16x16x32_bf16 v[44:47], v[132:135], v[36:39], v[44:47]
    ds_read_b128 v[36:39], v9 offset:0
    s_waitcnt lgkmcnt(6)
    v_mfma_f32_16x16x32_bf16 v[44:47], v[136:139], v[16:19], v[44:47]
    ds_read_b128 v[16:19], v9 offset:4032
    v_mfma_f32_16x16x32_bf16 v[44:47], v[140:143], v[20:23], v[44:47]
    ds_read_b128 v[20:23], v9 offset:3968
    s_waitcnt lgkmcnt(6)
    v_mfma_f32_16x16x32_bf16 v[44:47], v[144:147], v[24:27], v[44:47]
    ds_read_b128 v[24:27], v9 offset:3904
    v_mfma_f32_16x16x32_bf16 v[44:47], v[148:151], v[28:31], v[44:47]
    ds_read_b128 v[28:31], v9 offset:3840
    s_waitcnt lgkmcnt(4)
    v_mfma_f32_16x16x32_bf16 v[44:47], v[152:155], v[32:35], v[44:47]
    ds_read_b128 v[32:35], v9 offset:3776
    v_mfma_f32_16x16x32_bf16 v[44:47], v[156:159], v[36:39], v[44:47]
    ds_read_b128 v[36:39], v9 offset:3712
    s_waitcnt lgkmcnt(4)
    v_mfma_f32_16x16x32_bf16 v[44:47], v[64:67], v[16:19], v[44:47]
    ds_read_b128 v[16:19], v9 offset:3648
    v_mfma_f32_16x16x32_bf16 v[44:47], v[68:71], v[20:23], v[44:47]
    ds_read_b128 v[20:23], v9 offset:3584
    s_waitcnt lgkmcnt(4)
    v_mfma_f32_16x16x32_bf16 v[44:47], v[72:75], v[24:27], v[44:47]
    v_mfma_f32_16x16x32_bf16 v[44:47], v[76:79], v[28:31], v[44:47]
    s_waitcnt lgkmcnt(2)
    v_mfma_f32_16x16x32_bf16 v[44:47], v[80:83], v[32:35], v[44:47]
    v_mfma_f32_16x16x32_bf16 v[44:47], v[84:87], v[36:39], v[44:47]
    s_waitcnt lgkmcnt(0)
    v_mfma_f32_16x16x32_bf16 v[44:47], v[88:91], v[16:19], v[44:47]
    v_mfma_f32_16x16x32_bf16 v[44:47], v[92:95], v[20:23], v[44:47]
    s_nop 7
    v_cvt_pk_bf16_f32 v14, v44, v45
    v_cvt_pk_bf16_f32 v15, v46, v47
    ds_write_b64 v10, v[14:15] offset:3584
    s_waitcnt lgkmcnt(0)
    s_barrier
    v_mov_b32 v1, s64
    v_mov_b32 v2, 0
    s_mov_b64 exec, 1
    global_store_dword v1, v2, s[36:37]
    s_mov_b64 exec, -1
    s_endpgm
L_BH1:
    s_mov_b32 s52, 0x05040100
    s_mov_b32 s53, 0x07060302
    s_mov_b32 s54, 0xffff
    v_and_b32 v16, 15, v0
    v_lshrrev_b32 v17, 4, v0
    s_lshl_b32 s55, s6, 4
    s_lshl_b32 s97, s4, 2
    s_add_u32 s55, s55, s97
    v_add_u32 v17, s55, v17
    v_mul_u32_u24 v63, 7168, v17
    v_lshl_add_u32 v63, v16, 3, v63
    s_lshl_b32 s55, s7, 7
    v_add_u32 v63, s55, v63
    v_add_u32 v63, 3584, v63
    s_add_u32 s68, s36, 4194304
    s_addc_u32 s69, s37, 0
    s_and_b32 s69, s69, 0xffff
    s_mov_b32 s70, 0x1c0000
    s_mov_b32 s71, 0x20000
    s_lshl_b32 s55, s7, 18
    s_lshl_b32 s97, s6, 10
    s_add_u32 s55, s55, s97
    s_lshl_b32 s97, s4, 8
    s_add_u32 s55, s55, s97
    v_lshrrev_b32 v17, 4, v0
    v_lshlrev_b32 v17, 4, v17
    v_lshl_add_u32 v17, v16, 14, v17
    v_add_u32 v56, s55, v17
    s_lshl_b32 s55, s7, 18
    s_lshl_b32 s97, s6, 14
    s_add_u32 s55, s55, s97
    s_lshl_b32 s97, s4, 9
    s_add_u32 s55, s55, s97
    v_bfe_u32 v17, v0, 1, 2
    v_lshrrev_b32 v16, 5, v0
    v_lshlrev_b32 v16, 8, v16
    v_lshl_add_u32 v16, v17, 6, v16
    v_bfe_u32 v17, v0, 3, 2
    v_lshl_add_u32 v16, v17, 4, v16
    v_and_b32 v17, 1, v0
    v_lshl_add_u32 v16, v17, 3, v16
    v_add_u32 v57, s55, v16
    s_lshl_b32 s55, s7, 8
    s_add_u32 s55, s55, 6295040
    v_lshl_add_u32 v60, v0, 2, s55
    s_lshl_b32 s64, s6, 4
    s_lshl_b32 s97, s4, 2
    s_add_u32 s64, s64, s97
    s_add_u32 s64, s64, s55
    v_mov_b32 v61, s64
    s_getreg_b32 s65, hwreg(HW_REG_XCC_ID, 0, 4)
    s_add_u32 s65, s65, 1
    s_mul_i32 s65, s65, 0x9e3779b9
    s_xor_b32 s65, s65, 0x6b8b4567
    v_mov_b32 v62, s65
    global_load_dword v255, v60, s[36:37] sc1
    v_bfe_u32 v16, v0, 2, 2
    v_and_b32 v17, 3, v0
    v_lshrrev_b32 v18, 4, v0
    v_add_u32 v17, s4, v17
    v_and_b32 v17, 3, v17
    v_lshl_add_u32 v17, v18, 2, v17
    v_mul_u32_u24 v16, 4160, v16
    v_lshl_add_u32 v16, v17, 3, v16
    s_lshl_b32 s55, s4, 7
    s_add_u32 s55, s55, 66560
    v_add_u32 v8, s55, v16
    s_mov_b32 s40, s34
    s_and_b32 s41, s35, 0xffff
    s_mov_b32 s42, 0x380000
    s_mov_b32 s43, 0x20000
    s_mul_i32 s55, s4, 114688
    s_lshl_b32 s97, s5, 1
    s_add_u32 s55, s55, s97
    s_add_u32 s55, s55, 896
    v_mul_u32_u24 v16, 1792, v0
    v_add_u32 v9, s55, v16
    s_mov_b32 s89, 458752
    s_mov_b32 s90, 917504
    s_mov_b32 s91, 1376256
    s_mov_b32 s92, 1835008
    s_mov_b32 s93, 2293760
    s_mov_b32 s94, 2752512
    s_mov_b32 s95, 3211264
    s_lshl_b32 s55, s4, 2
    s_add_u32 s55, s55, 161280
    v_mov_b32 v16, s55
    v_mov_b32 v17, 0
    ds_write_b32 v16, v17
    v_mov_b32 v6, 161280
    s_movk_i32 s81, 2048
    s_movk_i32 s82, 4096
    s_movk_i32 s83, 6144
    s_movk_i32 s84, 8192
    s_movk_i32 s85, 10240
    s_movk_i32 s86, 12288
    s_movk_i32 s87, 14336
    s_mul_i32 s96, s4, 16640
    s_add_u32 s96, s96, 1008
    v_sub_u32 v4, s96, v1
    v_bfe_u32 v3, v0, 3, 2
    v_mul_u32_u24 v3, 4160, v3
    v_and_b32 v7, 7, v0
    v_lshl_add_u32 v3, v7, 2, v3
    s_mul_i32 s55, s4, 16640
    s_add_u32 s55, s55, 4096
    v_add_u32 v3, s55, v3
    v_mov_b32 v7, 0
    ds_write_b32 v3, v7
    s_lshl_b32 s55, s4, 4
    s_waitcnt lgkmcnt(0)
    s_lshr_b64 s[72:73], s[72:73], s55
    s_lshl_b32 s62, s72, 16
    s_waitcnt vmcnt(7)
    v_lshlrev_b32 v3, 16, v66
    v_and_b32 v7, 0xffff0000, v66
    v_add_f32 v3, s62, v3
    s_mov_b64 exec, 1
    v_cvt_pk_bf16_f32 v66, v3, v7
    s_mov_b64 exec, -1
    v_bfi_b32 v96, s54, v68, v67
    v_bfi_b32 v97, s54, v67, v66
    v_bfi_b32 v98, s54, v66, v65
    v_bfi_b32 v99, s54, v65, v64
    ds_write_b128 v4, v[96:99] offset:3072
    v_alignbit_b32 v100, v68, v68, 16
    v_alignbit_b32 v101, v67, v67, 16
    v_alignbit_b32 v102, v66, v66, 16
    v_alignbit_b32 v103, v65, v65, 16
    ds_write_b128 v4, v[100:103] offset:7232
    v_bfi_b32 v104, s54, v69, v68
    v_bfi_b32 v105, s54, v68, v67
    v_bfi_b32 v106, s54, v67, v66
    v_bfi_b32 v107, s54, v66, v65
    ds_write_b128 v4, v[104:107] offset:11392
    v_alignbit_b32 v108, v69, v69, 16
    v_alignbit_b32 v109, v68, v68, 16
    v_alignbit_b32 v110, v67, v67, 16
    v_alignbit_b32 v111, v66, v66, 16
    ds_write_b128 v4, v[108:111] offset:15552
    s_waitcnt vmcnt(5)
    v_bfi_b32 v112, s54, v74, v73
    v_bfi_b32 v113, s54, v73, v72
    v_bfi_b32 v114, s54, v72, v71
    v_bfi_b32 v115, s54, v71, v70
    ds_write_b128 v4, v[112:115] offset:2048
    v_alignbit_b32 v116, v74, v74, 16
    v_alignbit_b32 v117, v73, v73, 16
    v_alignbit_b32 v118, v72, v72, 16
    v_alignbit_b32 v119, v71, v71, 16
    ds_write_b128 v4, v[116:119] offset:6208
    v_bfi_b32 v120, s54, v75, v74
    v_bfi_b32 v121, s54, v74, v73
    v_bfi_b32 v122, s54, v73, v72
    v_bfi_b32 v123, s54, v72, v71
    ds_write_b128 v4, v[120:123] offset:10368
    v_alignbit_b32 v124, v75, v75, 16
    v_alignbit_b32 v125, v74, v74, 16
    v_alignbit_b32 v126, v73, v73, 16
    v_alignbit_b32 v127, v72, v72, 16
    ds_write_b128 v4, v[124:127] offset:14528
    s_waitcnt vmcnt(3)
    v_bfi_b32 v96, s54, v80, v79
    v_bfi_b32 v97, s54, v79, v78
    v_bfi_b32 v98, s54, v78, v77
    v_bfi_b32 v99, s54, v77, v76
    ds_write_b128 v4, v[96:99] offset:1024
    v_alignbit_b32 v100, v80, v80, 16
    v_alignbit_b32 v101, v79, v79, 16
    v_alignbit_b32 v102, v78, v78, 16
    v_alignbit_b32 v103, v77, v77, 16
    ds_write_b128 v4, v[100:103] offset:5184
    v_bfi_b32 v104, s54, v81, v80
    v_bfi_b32 v105, s54, v80, v79
    v_bfi_b32 v106, s54, v79, v78
    v_bfi_b32 v107, s54, v78, v77
    ds_write_b128 v4, v[104:107] offset:9344
    v_alignbit_b32 v108, v81, v81, 16
    v_alignbit_b32 v109, v80, v80, 16
    v_alignbit_b32 v110, v79, v79, 16
    v_alignbit_b32 v111, v78, v78, 16
    ds_write_b128 v4, v[108:111] offset:13504
    s_waitcnt vmcnt(1)
    v_bfi_b32 v112, s54, v86, v85
    v_bfi_b32 v113, s54, v85, v84
    v_bfi_b32 v114, s54, v84, v83
    v_bfi_b32 v115, s54, v83, v82
    ds_write_b128 v4, v[112:115] offset:0
    v_alignbit_b32 v116, v86, v86, 16
    v_alignbit_b32 v117, v85, v85, 16
    v_alignbit_b32 v118, v84, v84, 16
    v_alignbit_b32 v119, v83, v83, 16
    ds_write_b128 v4, v[116:119] offset:4160
    v_bfi_b32 v120, s54, v87, v86
    v_bfi_b32 v121, s54, v86, v85
    v_bfi_b32 v122, s54, v85, v84
    v_bfi_b32 v123, s54, v84, v83
    ds_write_b128 v4, v[120:123] offset:8320
    v_alignbit_b32 v124, v87, v87, 16
    v_alignbit_b32 v125, v86, v86, 16
    v_alignbit_b32 v126, v85, v85, 16
    v_alignbit_b32 v127, v84, v84, 16
    ds_write_b128 v4, v[124:127] offset:12480
    s_setprio 1
    s_waitcnt lgkmcnt(0)
    s_barrier
    s_movk_i32 s66, 64
L_Q_POLL:
    s_sub_u32 s66, s66, 1
    s_cbranch_scc1 L_Q_FAIL
    global_load_dword v16, v60, s[36:37] sc1
    s_waitcnt vmcnt(0)
    v_cmp_ne_u32 vcc, s65, v16
    s_nop 1
    s_cbranch_vccnz L_Q_POLL
L_Q_GOT:
    buffer_load_dwordx2 v[32:33], v57, s[68:71], 0 offen sc1 nt
    buffer_load_dwordx2 v[34:35], v57, s[68:71], s81 offen sc1 nt
    buffer_load_dwordx2 v[36:37], v57, s[68:71], s82 offen sc1 nt
    buffer_load_dwordx2 v[38:39], v57, s[68:71], s83 offen sc1 nt
    buffer_load_dwordx2 v[40:41], v57, s[68:71], s84 offen sc1 nt
    buffer_load_dwordx2 v[42:43], v57, s[68:71], s85 offen sc1 nt
    buffer_load_dwordx2 v[44:45], v57, s[68:71], s86 offen sc1 nt
    buffer_load_dwordx2 v[46:47], v57, s[68:71], s87 offen sc1 nt
    s_setprio 1
L_WT_1_0:
    ds_read_b128 v[12:15], v6
    s_waitcnt lgkmcnt(0)
    v_min_u32 v12, v12, v13
    v_min3_u32 v12, v12, v14, v15
    s_nop 0
    v_readfirstlane_b32 s55, v12
    s_nop 0
    s_cmp_ge_u32 s55, 2
    s_cbranch_scc1 L_WT_1_0_OK
    s_branch L_WT_1_0
L_WT_1_0_OK:
    ds_read_b64_tr_b16 v[16:17], v8 offset:0
    s_waitcnt vmcnt(7)
    v_lshlrev_b32 v64, 16, v32
    v_and_b32 v65, 0xffff0000, v32
    v_lshlrev_b32 v66, 16, v33
    v_and_b32 v67, 0xffff0000, v33
    s_waitcnt lgkmcnt(0)
    v_lshlrev_b32 v10, 16, v16
    v_and_b32 v11, 0xffff0000, v16
    v_lshlrev_b32 v12, 16, v17
    v_and_b32 v13, 0xffff0000, v17
    v_mul_f32 v10, v10, v64
    v_mul_f32 v11, v11, v65
    v_mul_f32 v12, v12, v66
    v_mul_f32 v13, v13, v67
    v_cvt_pk_bf16_f32 v16, v10, v11
    v_cvt_pk_bf16_f32 v17, v12, v13
    buffer_store_dwordx2 v[16:17], v9, s[40:43], 0 offen
    s_waitcnt vmcnt(7)
    v_lshlrev_b32 v68, 16, v34
    v_and_b32 v69, 0xffff0000, v34
    v_lshlrev_b32 v70, 16, v35
    v_and_b32 v71, 0xffff0000, v35
L_WT_1_1:
    ds_read_b128 v[12:15], v6
    s_waitcnt lgkmcnt(0)
    v_min_u32 v12, v12, v13
    v_min3_u32 v12, v12, v14, v15
    s_nop 0
    v_readfirstlane_b32 s55, v12
    s_nop 0
    s_cmp_ge_u32 s55, 3
    s_cbranch_scc1 L_WT_1_1_OK
    s_branch L_WT_1_1
L_WT_1_1_OK:
    ds_read_b64_tr_b16 v[18:19], v8 offset:512
    s_waitcnt lgkmcnt(0)
    v_lshlrev_b32 v10, 16, v18
    v_and_b32 v11, 0xffff0000, v18
    v_lshlrev_b32 v12, 16, v19
    v_and_b32 v13, 0xffff0000, v19
    v_mul_f32 v10, v10, v68
    v_mul_f32 v11, v11, v69
    v_mul_f32 v12, v12, v70
    v_mul_f32 v13, v13, v71
    v_cvt_pk_bf16_f32 v18, v10, v11
    v_cvt_pk_bf16_f32 v19, v12, v13
    buffer_store_dwordx2 v[18:19], v9, s[40:43], s89 offen
    s_waitcnt vmcnt(7)
    v_lshlrev_b32 v72, 16, v36
    v_and_b32 v73, 0xffff0000, v36
    v_lshlrev_b32 v74, 16, v37
    v_and_b32 v75, 0xffff0000, v37
    s_waitcnt vmcnt(6)
    v_lshlrev_b32 v76, 16, v38
    v_and_b32 v77, 0xffff0000, v38
    v_lshlrev_b32 v78, 16, v39
    v_and_b32 v79, 0xffff0000, v39
L_WT_1_2:
    ds_read_b128 v[12:15], v6
    s_waitcnt lgkmcnt(0)
    v_min_u32 v12, v12, v13
    v_min3_u32 v12, v12, v14, v15
    s_nop 0
    v_readfirstlane_b32 s55, v12
    s_nop 0
    s_cmp_ge_u32 s55, 4
    s_cbranch_scc1 L_WT_1_2_OK
    s_branch L_WT_1_2
L_WT_1_2_OK:
    ds_read_b64_tr_b16 v[20:21], v8 offset:1024
    ds_read_b64_tr_b16 v[22:23], v8 offset:1536
    s_waitcnt lgkmcnt(1)
    v_lshlrev_b32 v10, 16, v20
    v_and_b32 v11, 0xffff0000, v20
    v_lshlrev_b32 v12, 16, v21
    v_and_b32 v13, 0xffff0000, v21
    v_mul_f32 v10, v10, v72
    v_mul_f32 v11, v11, v73
    v_mul_f32 v12, v12, v74
    v_mul_f32 v13, v13, v75
    v_cvt_pk_bf16_f32 v20, v10, v11
    v_cvt_pk_bf16_f32 v21, v12, v13
    buffer_store_dwordx2 v[20:21], v9, s[40:43], s90 offen
    s_waitcnt lgkmcnt(0)
    v_lshlrev_b32 v10, 16, v22
    v_and_b32 v11, 0xffff0000, v22
    v_lshlrev_b32 v12, 16, v23
    v_and_b32 v13, 0xffff0000, v23
    v_mul_f32 v10, v10, v76
    v_mul_f32 v11, v11, v77
    v_mul_f32 v12, v12, v78
    v_mul_f32 v13, v13, v79
    v_cvt_pk_bf16_f32 v22, v10, v11
    v_cvt_pk_bf16_f32 v23, v12, v13
    buffer_store_dwordx2 v[22:23], v9, s[40:43], s91 offen
    s_waitcnt vmcnt(7)
    v_lshlrev_b32 v80, 16, v40
    v_and_b32 v81, 0xffff0000, v40
    v_lshlrev_b32 v82, 16, v41
    v_and_b32 v83, 0xffff0000, v41
    s_waitcnt vmcnt(6)
    v_lshlrev_b32 v84, 16, v42
    v_and_b32 v85, 0xffff0000, v42
    v_lshlrev_b32 v86, 16, v43
    v_and_b32 v87, 0xffff0000, v43
L_WT_1_3:
    ds_read_b128 v[12:15], v6
    s_waitcnt lgkmcnt(0)
    v_min_u32 v12, v12, v13
    v_min3_u32 v12, v12, v14, v15
    s_nop 0
    v_readfirstlane_b32 s55, v12
    s_nop 0
    s_cmp_ge_u32 s55, 5
    s_cbranch_scc1 L_WT_1_3_OK
    s_branch L_WT_1_3
L_WT_1_3_OK:
    ds_read_b64_tr_b16 v[24:25], v8 offset:2048
    ds_read_b64_tr_b16 v[26:27], v8 offset:2560
    s_waitcnt lgkmcnt(1)
    v_lshlrev_b32 v10, 16, v24
    v_and_b32 v11, 0xffff0000, v24
    v_lshlrev_b32 v12, 16, v25
    v_and_b32 v13, 0xffff0000, v25
    v_mul_f32 v10, v10, v80
    v_mul_f32 v11, v11, v81
    v_mul_f32 v12, v12, v82
    v_mul_f32 v13, v13, v83
    v_cvt_pk_bf16_f32 v24, v10, v11
    v_cvt_pk_bf16_f32 v25, v12, v13
    buffer_store_dwordx2 v[24:25], v9, s[40:43], s92 offen
    s_waitcnt lgkmcnt(0)
    v_lshlrev_b32 v10, 16, v26
    v_and_b32 v11, 0xffff0000, v26
    v_lshlrev_b32 v12, 16, v27
    v_and_b32 v13, 0xffff0000, v27
    v_mul_f32 v10, v10, v84
    v_mul_f32 v11, v11, v85
    v_mul_f32 v12, v12, v86
    v_mul_f32 v13, v13, v87
    v_cvt_pk_bf16_f32 v26, v10, v11
    v_cvt_pk_bf16_f32 v27, v12, v13
    buffer_store_dwordx2 v[26:27], v9, s[40:43], s93 offen
    s_waitcnt vmcnt(7)
    v_lshlrev_b32 v88, 16, v44
    v_and_b32 v89, 0xffff0000, v44
    v_lshlrev_b32 v90, 16, v45
    v_and_b32 v91, 0xffff0000, v45
L_WT_1_4:
    ds_read_b128 v[12:15], v6
    s_waitcnt lgkmcnt(0)
    v_min_u32 v12, v12, v13
    v_min3_u32 v12, v12, v14, v15
    s_nop 0
    v_readfirstlane_b32 s55, v12
    s_nop 0
    s_cmp_ge_u32 s55, 6
    s_cbranch_scc1 L_WT_1_4_OK
    s_branch L_WT_1_4
L_WT_1_4_OK:
    ds_read_b64_tr_b16 v[28:29], v8 offset:3072
    s_waitcnt lgkmcnt(0)
    v_lshlrev_b32 v10, 16, v28
    v_and_b32 v11, 0xffff0000, v28
    v_lshlrev_b32 v12, 16, v29
    v_and_b32 v13, 0xffff0000, v29
    v_mul_f32 v10, v10, v88
    v_mul_f32 v11, v11, v89
    v_mul_f32 v12, v12, v90
    v_mul_f32 v13, v13, v91
    v_cvt_pk_bf16_f32 v28, v10, v11
    v_cvt_pk_bf16_f32 v29, v12, v13
    buffer_store_dwordx2 v[28:29], v9, s[40:43], s94 offen
    s_waitcnt vmcnt(7)
    v_lshlrev_b32 v92, 16, v46
    v_and_b32 v93, 0xffff0000, v46
    v_lshlrev_b32 v94, 16, v47
    v_and_b32 v95, 0xffff0000, v47
    s_barrier
    ds_read_b64_tr_b16 v[30:31], v8 offset:3584
    s_waitcnt lgkmcnt(0)
    v_lshlrev_b32 v10, 16, v30
    v_and_b32 v11, 0xffff0000, v30
    v_lshlrev_b32 v12, 16, v31
    v_and_b32 v13, 0xffff0000, v31
    v_mul_f32 v10, v10, v92
    v_mul_f32 v11, v11, v93
    v_mul_f32 v12, v12, v94
    v_mul_f32 v13, v13, v95
    v_cvt_pk_bf16_f32 v30, v10, v11
    v_cvt_pk_bf16_f32 v31, v12, v13
    buffer_store_dwordx2 v[30:31], v9, s[40:43], s95 offen
    s_endpgm
L_A_FAIL:
    s_add_u32 s55, s5, s4
    s_lshl_b32 s55, s55, 1
    v_mul_u32_u24 v16, 896, v0
    v_add_u32 v16, s55, v16
    v_lshl_add_u32 v17, v0, 1, m0
    v_mov_b32 v18, 0
    v_mov_b32 v19, 0
    v_mov_b32 v20, 0
    v_mov_b32 v21, 0
    v_mov_b32 v22, 0
    v_mov_b32 v23, 0
    s_movk_i32 s66, 32
L_A_FB:
    global_load_ushort v18, v16, s[8:9]
    s_waitcnt vmcnt(0)
    ds_write_b16 v17, v18
    v_add_u32 v16, 57344, v16
    v_add_u32 v17, 128, v17
    s_sub_u32 s66, s66, 1
    s_cmp_lg_u32 s66, 0
    s_cbranch_scc1 L_A_FB
    s_waitcnt lgkmcnt(0)
    s_branch L_A_GOT
L_B_FAIL:
    s_add_u32 s55, s5, s4
    s_lshl_b32 s96, s55, 3
    s_load_dwordx2 s[72:73], s[28:29], s96
    s_lshl_b32 s55, s55, 1
    v_mul_u32_u24 v16, 896, v0
    v_add_u32 v16, s55, v16
    v_lshl_add_u32 v17, v0, 1, m0
    v_mov_b32 v18, 0
    v_mov_b32 v19, 0
    v_mov_b32 v20, 0
    v_mov_b32 v21, 0
    v_mov_b32 v22, 0
    v_mov_b32 v23, 0
    s_waitcnt lgkmcnt(0)
    s_and_b32 s74, s72, 0xffff0000
    s_lshl_b32 s72, s72, 16
    s_and_b32 s75, s73, 0xffff0000
    s_lshl_b32 s73, s73, 16
    s_movk_i32 s66, 32
L_B_FB:
    buffer_load_short_d16_hi v18, v16, s[44:47], 0 offen
    v_subrev_u32 v25, 896, v16
    buffer_load_short_d16_hi v19, v25, s[44:47], 0 offen
    v_subrev_u32 v26, 1792, v16
    buffer_load_short_d16_hi v20, v26, s[44:47], 0 offen
    v_subrev_u32 v27, 2688, v16
    buffer_load_short_d16_hi v21, v27, s[44:47], 0 offen
    global_load_short_d16_hi v22, v16, s[26:27]
    s_waitcnt vmcnt(0)
    v_mul_f32 v23, s75, v21
    v_fmac_f32 v23, s73, v20
    v_fmac_f32 v23, s74, v19
    v_fmac_f32 v23, s72, v18
    v_mul_f32 v23, v23, v22
    v_cvt_pk_bf16_f32 v23, v23, v23
    ds_write_b16 v17, v23
    v_add_u32 v16, 57344, v16
    v_add_u32 v17, 128, v17
    s_sub_u32 s66, s66, 1
    s_cmp_lg_u32 s66, 0
    s_cbranch_scc1 L_B_FB
    s_waitcnt lgkmcnt(0)
    s_branch L_B_GOT
L_Q_FAIL:
    s_mov_b32 s68, s22
    s_and_b32 s69, s23, 0xffff
    s_mov_b32 s70, 0x1c0000
    s_mov_b32 s71, 0x20000
    s_mul_i32 s96, s4, 57344
    s_lshl_b32 s97, s5, 1
    s_add_u32 s96, s96, s97
    v_mul_u32_u24 v57, 896, v0
    v_add_u32 v57, s96, v57
    s_mov_b32 s81, 229376
    s_mov_b32 s82, 458752
    s_mov_b32 s83, 688128
    s_mov_b32 s84, 917504
    s_mov_b32 s85, 1146880
    s_mov_b32 s86, 1376256
    s_mov_b32 s87, 1605632
    s_branch L_Q_GOT
L_END:
    s_endpgm
.p2align 7
.type L_TAB,@object
L_TAB:
    .long 0x00000000, 0x00000000, 0x00000000, 0x3f803f80
    .long 0x00000000, 0x00000000, 0x00000000, 0x3f800000
    .long 0x00000000, 0x00000000, 0x00000000, 0x00000000
    .long 0x00000000, 0x00000000, 0x00000000, 0x00000000
    .long 0x00000000, 0x00000000, 0x00000000, 0x00000000
    .long 0x00000000, 0x00000000, 0x00000000, 0x00000000
    .long 0x00000000, 0x00000000, 0x00000000, 0x00000000
    .long 0x00000000, 0x00000000, 0x00000000, 0x00000000
    .long 0x00000000, 0x00000000, 0x00000000, 0x00000000
    .long 0x00000000, 0x00000000, 0x00000000, 0x00000000
    .long 0x00000000, 0x00000000, 0x00000000, 0x00000000
    .long 0x00000000, 0x00000000, 0x00000000, 0x00000000
    .long 0x00000000, 0x00000000, 0x00000000, 0x00000000
    .long 0x00000000, 0x00000000, 0x00000000, 0x00000000
    .long 0x00000000, 0x00000000, 0x00000000, 0x00000000
    .long 0x00000000, 0x00000000, 0x00000000, 0x00000000
    .long 0x3f803f80, 0x00003f80, 0x00000000, 0x00000000
    .long 0x3f803f80, 0x3f803f80, 0x00000000, 0x00000000
    .long 0x3f803f80, 0x3f803f80, 0x00003f80, 0x00000000
    .long 0x3f800000, 0x3f803f80, 0x3f803f80, 0x00000000
    .long 0x00000000, 0x3f803f80, 0x3f803f80, 0x00003f80
    .long 0x00000000, 0x3f800000, 0x3f803f80, 0x3f803f80
    .long 0x00000000, 0x00000000, 0x3f803f80, 0x3f803f80
    .long 0x00000000, 0x00000000, 0x3f800000, 0x3f803f80
    .long 0x00000000, 0x00000000, 0x00000000, 0x3f803f80
    .long 0x00000000, 0x00000000, 0x00000000, 0x3f800000
    .long 0x00000000, 0x00000000, 0x00000000, 0x00000000
    .long 0x00000000, 0x00000000, 0x00000000, 0x00000000
    .long 0x00000000, 0x00000000, 0x00000000, 0x00000000
    .long 0x00000000, 0x00000000, 0x00000000, 0x00000000
    .long 0x00000000, 0x00000000, 0x00000000, 0x00000000
    .long 0x00000000, 0x00000000, 0x00000000, 0x00000000
    .long 0x00000000, 0x00000000, 0x00000000, 0x00000000
    .long 0x00000000, 0x00000000, 0x00000000, 0x00000000
    .long 0x00000000, 0x00000000, 0x00000000, 0x00000000
    .long 0x00000000, 0x00000000, 0x00000000, 0x00000000
    .long 0x00000000, 0x00000000, 0x00000000, 0x00000000
    .long 0x00000000, 0x00000000, 0x00000000, 0x00000000
    .long 0x00003f80, 0x00000000, 0x00000000, 0x00000000
    .long 0x3f803f80, 0x00000000, 0x00000000, 0x00000000
    .long 0x3f803f80, 0x00003f80, 0x00000000, 0x00000000
    .long 0x3f803f80, 0x3f803f80, 0x00000000, 0x00000000
    .long 0x3f803f80, 0x3f803f80, 0x00003f80, 0x00000000
    .long 0x3f800000, 0x3f803f80, 0x3f803f80, 0x00000000
    .long 0x00000000, 0x3f803f80, 0x3f803f80, 0x00003f80
    .long 0x00000000, 0x3f800000, 0x3f803f80, 0x3f803f80
    .long 0x00000000, 0x00000000, 0x3f803f80, 0x3f803f80
    .long 0x00000000, 0x00000000, 0x3f800000, 0x3f803f80
    .long 0x00000000, 0x00000000, 0x00000000, 0x00000000
    .long 0x00000000, 0x00000000, 0x00000000, 0x00000000
    .long 0x00000000, 0x00000000, 0x00000000, 0x00000000
    .long 0x00000000, 0x00000000, 0x00000000, 0x00000000
    .long 0x00000000, 0x00000000, 0x00000000, 0x00000000
    .long 0x00000000, 0x00000000, 0x00000000, 0x00000000
    .long 0x00000000, 0x00000000, 0x00000000, 0x00000000
    .long 0x00000000, 0x00000000, 0x00000000, 0x00000000
    .long 0x00000000, 0x00000000, 0x00000000, 0x00000000
    .long 0x00000000, 0x00000000, 0x00000000, 0x00000000
    .long 0x00000000, 0x00000000, 0x00000000, 0x00000000
    .long 0x00000000, 0x00000000, 0x00000000, 0x00000000
    .long 0x00000000, 0x00000000, 0x00000000, 0x00000000
    .long 0x00000000, 0x00000000, 0x00000000, 0x00000000
    .long 0x00003f80, 0x00000000, 0x00000000, 0x00000000
    .long 0x3f803f80, 0x00000000, 0x00000000, 0x00000000
    .long 0x00000000, 0x00000000, 0x00000000, 0x3f803f80
    .long 0x00000000, 0x00000000, 0x00000000, 0x3f800000
    .long 0x00000000, 0x00000000, 0x00000000, 0x00000000
    .long 0x00000000, 0x00000000, 0x00000000, 0x00000000
    .long 0x00000000, 0x00000000, 0x00000000, 0x00000000
    .long 0x00000000, 0x00000000, 0x00000000, 0x00000000
    .long 0x00000000, 0x00000000, 0x00000000, 0x00000000
    .long 0x00000000, 0x00000000, 0x00000000, 0x00000000
    .long 0x00000000, 0x00000000, 0x00000000, 0x00000000
    .long 0x00000000, 0x00000000, 0x00000000, 0x00000000
    .long 0x00000000, 0x00000000, 0x00000000, 0x00000000
    .long 0x00000000, 0x00000000, 0x00000000, 0x00000000
    .long 0x00000000, 0x00000000, 0x00000000, 0x00000000
    .long 0x00000000, 0x00000000, 0x00000000, 0x00000000
    .long 0x00000000, 0x00000000, 0x00000000, 0x00000000
    .long 0x00000000, 0x00000000, 0x00000000, 0x00000000
    .long 0x3f803f80, 0x00003f80, 0x00000000, 0x00000000
    .long 0x3f803f80, 0x3f803f80, 0x00000000, 0x00000000
    .long 0x3f803f80, 0x3f803f80, 0x00003f80, 0x00000000
    .long 0x3f800000, 0x3f803f80, 0x3f803f80, 0x00000000
    .long 0x00000000, 0x3f803f80, 0x3f803f80, 0x00003f80
    .long 0x00000000, 0x3f800000, 0x3f803f80, 0x3f803f80
    .long 0x00000000, 0x00000000, 0x3f803f80, 0x3f803f80
    .long 0x00000000, 0x00000000, 0x3f800000, 0x3f803f80
    .long 0x00000000, 0x00000000, 0x00000000, 0x3f803f80
    .long 0x00000000, 0x00000000, 0x00000000, 0x3f800000
    .long 0x00000000, 0x00000000, 0x00000000, 0x00000000
    .long 0x00000000, 0x00000000, 0x00000000, 0x00000000
    .long 0x00000000, 0x00000000, 0x00000000, 0x00000000
    .long 0x00000000, 0x00000000, 0x00000000, 0x00000000
    .long 0x00000000, 0x00000000, 0x00000000, 0x00000000
    .long 0x00000000, 0x00000000, 0x00000000, 0x00000000
    .long 0x00000000, 0x00000000, 0x00000000, 0x00000000
    .long 0x00000000, 0x00000000, 0x00000000, 0x00000000
    .long 0x00000000, 0x00000000, 0x00000000, 0x00000000
    .long 0x00000000, 0x00000000, 0x00000000, 0x00000000
    .long 0x00000000, 0x00000000, 0x00000000, 0x00000000
    .long 0x00000000, 0x00000000, 0x00000000, 0x00000000
    .long 0x00003f80, 0x00000000, 0x00000000, 0x00000000
    .long 0x3f803f80, 0x00000000, 0x00000000, 0x00000000
    .long 0x3f803f80, 0x00003f80, 0x00000000, 0x00000000
    .long 0x3f803f80, 0x3f803f80, 0x00000000, 0x00000000
    .long 0x3f803f80, 0x3f803f80, 0x00003f80, 0x00000000
    .long 0x3f800000, 0x3f803f80, 0x3f803f80, 0x00000000
    .long 0x00000000, 0x3f803f80, 0x3f803f80, 0x00003f80
    .long 0x00000000, 0x3f800000, 0x3f803f80, 0x3f803f80
    .long 0x00000000, 0x00000000, 0x3f803f80, 0x3f803f80
    .long 0x00000000, 0x00000000, 0x3f800000, 0x3f803f80
    .long 0x00000000, 0x00000000, 0x00000000, 0x00000000
    .long 0x00000000, 0x00000000, 0x00000000, 0x00000000
    .long 0x00000000, 0x00000000, 0x00000000, 0x00000000
    .long 0x00000000, 0x00000000, 0x00000000, 0x00000000
    .long 0x00000000, 0x00000000, 0x00000000, 0x00000000
    .long 0x00000000, 0x00000000, 0x00000000, 0x00000000
    .long 0x00000000, 0x00000000, 0x00000000, 0x00000000
    .long 0x00000000, 0x00000000, 0x00000000, 0x00000000
    .long 0x00000000, 0x00000000, 0x00000000, 0x00000000
    .long 0x00000000, 0x00000000, 0x00000000, 0x00000000
    .long 0x00000000, 0x00000000, 0x00000000, 0x00000000
    .long 0x00000000, 0x00000000, 0x00000000, 0x00000000
    .long 0x00000000, 0x00000000, 0x00000000, 0x00000000
    .long 0x00000000, 0x00000000, 0x00000000, 0x00000000
    .long 0x00003f80, 0x00000000, 0x00000000, 0x00000000
    .long 0x3f803f80, 0x00000000, 0x00000000, 0x00000000
    .long 0x00000000, 0x00000000, 0x00000000, 0x00000000
    .long 0x00000000, 0x00000000, 0x00000000, 0x00000000
    .long 0x00000000, 0x00000000, 0x00000000, 0x00000000
    .long 0x00000000, 0x00000000, 0x00000000, 0x00000000
    .long 0x00000000, 0x00000000, 0x00000000, 0x00000000
    .long 0x00000000, 0x00000000, 0x00000000, 0x00000000
    .long 0x00000000, 0x00000000, 0x00000000, 0x00000000
    .long 0x00000000, 0x00000000, 0x00000000, 0x00000000
    .long 0x00000000, 0x00000000, 0x00000000, 0x00000000
    .long 0x00000000, 0x00000000, 0x00000000, 0x00000000
    .long 0x00000000, 0x00000000, 0x00000000, 0x00000000
    .long 0x00000000, 0x00000000, 0x00000000, 0x00000000
    .long 0x00000000, 0x00000000, 0x00000000, 0x00000000
    .long 0x00000000, 0x00000000, 0x00000000, 0x00000000
    .long 0x00000000, 0x00000000, 0x00000000, 0x00000000
    .long 0x00000000, 0x00000000, 0x00000000, 0x00000000
    .long 0x00000000, 0x3f800000, 0x3f803f80, 0x00000000
    .long 0x00000000, 0x00000000, 0x3f803f80, 0x00003f80
    .long 0x00000000, 0x00000000, 0x3f800000, 0x3f803f80
    .long 0x00000000, 0x00000000, 0x00000000, 0x3f803f80
    .long 0x00000000, 0x00000000, 0x00000000, 0x3f800000
    .long 0x00000000, 0x00000000, 0x00000000, 0x00000000
    .long 0x00000000, 0x00000000, 0x00000000, 0x00000000
    .long 0x00000000, 0x00000000, 0x00000000, 0x00000000
    .long 0x00000000, 0x00000000, 0x00000000, 0x00000000
    .long 0x00000000, 0x00000000, 0x00000000, 0x00000000
    .long 0x00000000, 0x00000000, 0x00000000, 0x00000000
    .long 0x00000000, 0x00000000, 0x00000000, 0x00000000
    .long 0x00000000, 0x00000000, 0x00000000, 0x00000000
    .long 0x00000000, 0x00000000, 0x00000000, 0x00000000
    .long 0x00000000, 0x00000000, 0x00000000, 0x00000000
    .long 0x00000000, 0x00000000, 0x00000000, 0x00000000
    .long 0x00000000, 0x00000000, 0x00000000, 0x00000000
    .long 0x00000000, 0x00000000, 0x00000000, 0x00000000
    .long 0x00000000, 0x00000000, 0x00000000, 0x00000000
    .long 0x00003f80, 0x00000000, 0x00000000, 0x00000000
    .long 0x3f803f80, 0x00000000, 0x00000000, 0x00000000
    .long 0x3f803f80, 0x00003f80, 0x00000000, 0x00000000
    .long 0x3f800000, 0x3f803f80, 0x00000000, 0x00000000
    .long 0x00000000, 0x3f803f80, 0x00003f80, 0x00000000
    .long 0x00000000, 0x3f800000, 0x3f803f80, 0x00000000
    .long 0x00000000, 0x00000000, 0x3f803f80, 0x00003f80
    .long 0x00000000, 0x00000000, 0x3f800000, 0x3f803f80
    .long 0x00000000, 0x00000000, 0x00000000, 0x3f803f80
    .long 0x00000000, 0x00000000, 0x00000000, 0x3f800000
    .long 0x00000000, 0x00000000, 0x00000000, 0x00000000
    .long 0x00000000, 0x00000000, 0x00000000, 0x00000000
    .long 0x00000000, 0x00000000, 0x00000000, 0x00000000
    .long 0x00000000, 0x00000000, 0x00000000, 0x00000000
    .long 0x00000000, 0x00000000, 0x00000000, 0x00000000
    .long 0x00000000, 0x00000000, 0x00000000, 0x00000000
    .long 0x00000000, 0x00000000, 0x00000000, 0x00000000
    .long 0x00000000, 0x00000000, 0x00000000, 0x00000000
    .long 0x00000000, 0x00000000, 0x00000000, 0x00000000
    .long 0x00000000, 0x00000000, 0x00000000, 0x00000000
    .long 0x00000000, 0x00000000, 0x00000000, 0x00000000
    .long 0x00000000, 0x00000000, 0x00000000, 0x00000000
    .long 0x00000000, 0x00000000, 0x00000000, 0x00000000
    .long 0x00000000, 0x00000000, 0x00000000, 0x00000000
    .long 0x00003f80, 0x00000000, 0x00000000, 0x00000000
    .long 0x3f803f80, 0x00000000, 0x00000000, 0x00000000
    .long 0x3f803f80, 0x00003f80, 0x00000000, 0x00000000
    .long 0x3f800000, 0x3f803f80, 0x00000000, 0x00000000
    .long 0x00000000, 0x3f803f80, 0x00003f80, 0x00000000
    .long 0x00000000, 0x3f800000, 0x3f803f80, 0x00000000
    .long 0x00000000, 0x00000000, 0x3f803f80, 0x00003f80
    .long 0x00000000, 0x00000000, 0x3f800000, 0x3f803f80
    .long 0x00000000, 0x00000000, 0x00000000, 0x3f803f80
    .long 0x00000000, 0x00000000, 0x00000000, 0x3f800000
    .long 0x00000000, 0x00000000, 0x00000000, 0x00000000
    .long 0x00000000, 0x00000000, 0x00000000, 0x00000000
    .long 0x00000000, 0x00000000, 0x00000000, 0x00000000
    .long 0x00000000, 0x00000000, 0x00000000, 0x00000000
    .long 0x00000000, 0x00000000, 0x00000000, 0x00000000
    .long 0x00000000, 0x00000000, 0x00000000, 0x00000000
    .long 0x00000000, 0x00000000, 0x00000000, 0x00000000
    .long 0x00000000, 0x00000000, 0x00000000, 0x00000000
    .long 0x00000000, 0x00000000, 0x00000000, 0x00000000
    .long 0x00000000, 0x00000000, 0x00000000, 0x00000000
    .long 0x00000000, 0x00000000, 0x00000000, 0x00000000
    .long 0x00000000, 0x00000000, 0x00000000, 0x00000000
    .long 0x00000000, 0x00000000, 0x00000000, 0x00000000
    .long 0x00000000, 0x00000000, 0x00000000, 0x00000000
    .long 0x00003f80, 0x00000000, 0x00000000, 0x00000000
    .long 0x3f803f80, 0x00000000, 0x00000000, 0x00000000
    .long 0x3f803f80, 0x00003f80, 0x00000000, 0x00000000
    .long 0x3f800000, 0x3f803f80, 0x00000000, 0x00000000
    .long 0x00000000, 0x3f803f80, 0x00003f80, 0x00000000
    .long 0x00000000, 0x3f800000, 0x3f803f80, 0x00000000
    .long 0x00000000, 0x00000000, 0x3f803f80, 0x00003f80
    .long 0x00000000, 0x00000000, 0x3f800000, 0x3f803f80
    .long 0x00000000, 0x00000000, 0x00000000, 0x3f803f80
    .long 0x00000000, 0x00000000, 0x00000000, 0x3f800000
    .long 0x00000000, 0x00000000, 0x00000000, 0x00000000
    .long 0x00000000, 0x00000000, 0x00000000, 0x00000000
    .long 0x00000000, 0x00000000, 0x00000000, 0x00000000
    .long 0x00000000, 0x00000000, 0x00000000, 0x00000000
    .long 0x00000000, 0x00000000, 0x00000000, 0x00000000
    .long 0x00000000, 0x00000000, 0x00000000, 0x00000000
    .long 0x00000000, 0x00000000, 0x00000000, 0x00000000
    .long 0x00000000, 0x00000000, 0x00000000, 0x00000000
    .long 0x00000000, 0x00000000, 0x00000000, 0x00000000
    .long 0x00000000, 0x00000000, 0x00000000, 0x00000000
    .long 0x00000000, 0x00000000, 0x00000000, 0x00000000
    .long 0x00000000, 0x00000000, 0x00000000, 0x00000000
    .long 0x00000000, 0x00000000, 0x00000000, 0x00000000
    .long 0x00000000, 0x00000000, 0x00000000, 0x00000000
    .long 0x00003f80, 0x00000000, 0x00000000, 0x00000000
    .long 0x3f803f80, 0x00000000, 0x00000000, 0x00000000
    .long 0x3f803f80, 0x00003f80, 0x00000000, 0x00000000
    .long 0x3f800000, 0x3f803f80, 0x00000000, 0x00000000
    .long 0x00000000, 0x3f803f80, 0x00003f80, 0x00000000
    .long 0x00000000, 0x00000000, 0x00000000, 0x00000000
    .long 0x00000000, 0x00000000, 0x00000000, 0x00000000
    .long 0x00000000, 0x00000000, 0x00000000, 0x00000000
    .long 0x00000000, 0x00000000, 0x00000000, 0x00000000
    .long 0x00000000, 0x00000000, 0x00000000, 0x00000000
    .long 0x00000000, 0x00000000, 0x00000000, 0x00000000
    .long 0x00000000, 0x00000000, 0x00000000, 0x00000000
    .long 0x00000000, 0x00000000, 0x00000000, 0x00000000
    .long 0x00000000, 0x00000000, 0x00000000, 0x00000000
    .long 0x00000000, 0x00000000, 0x00000000, 0x00000000
    .long 0x00000000, 0x00000000, 0x00000000, 0x00000000
    .long 0x00000000, 0x00000000, 0x00000000, 0x00000000
    .long 0x00000000, 0x00000000, 0x00000000, 0x00000000
    .long 0x00000000, 0x00000000, 0x00000000, 0x00000000
    .long 0x00000000, 0x00000000, 0x00000000, 0x00000000
    .long 0x00000000, 0x00000000, 0x00000000, 0x00000000
    .long 0x00000000, 0x00000000, 0x3f803f80, 0x3f803f80
    .long 0x00000000, 0x00000000, 0x3f800000, 0x3f803f80
    .long 0x00000000, 0x00000000, 0x00000000, 0x3f803f80
    .long 0x00000000, 0x00000000, 0x00000000, 0x3f800000
    .long 0x00000000, 0x00000000, 0x00000000, 0x00000000
    .long 0x00000000, 0x00000000, 0x00000000, 0x00000000
    .long 0x00000000, 0x00000000, 0x00000000, 0x00000000
    .long 0x00000000, 0x00000000, 0x00000000, 0x00000000
    .long 0x00000000, 0x00000000, 0x00000000, 0x00000000
    .long 0x00000000, 0x00000000, 0x00000000, 0x00000000
    .long 0x00000000, 0x00000000, 0x00000000, 0x00000000
    .long 0x00000000, 0x00000000, 0x00000000, 0x00000000
    .long 0x00000000, 0x00000000, 0x00000000, 0x00000000
    .long 0x00000000, 0x00000000, 0x00000000, 0x00000000
    .long 0x00000000, 0x00000000, 0x00000000, 0x00000000
    .long 0x00000000, 0x00000000, 0x00000000, 0x00000000
    .long 0x3f803f80, 0x3f803f80, 0x00003f80, 0x00000000
    .long 0x3f803f80, 0x3f803f80, 0x3f803f80, 0x00000000
    .long 0x3f803f80, 0x3f803f80, 0x3f803f80, 0x00003f80
    .long 0x3f803f80, 0x3f803f80, 0x3f803f80, 0x3f803f80
    .long 0x3f803f80, 0x3f803f80, 0x3f803f80, 0x3f803f80
    .long 0x3f800000, 0x3f803f80, 0x3f803f80, 0x3f803f80
    .long 0x00000000, 0x3f803f80, 0x3f803f80, 0x3f803f80
    .long 0x00000000, 0x3f800000, 0x3f803f80, 0x3f803f80
    .long 0x00000000, 0x00000000, 0x3f803f80, 0x3f803f80
    .long 0x00000000, 0x00000000, 0x3f800000, 0x3f803f80
    .long 0x00000000, 0x00000000, 0x00000000, 0x3f803f80
    .long 0x00000000, 0x00000000, 0x00000000, 0x3f800000
    .long 0x00000000, 0x00000000, 0x00000000, 0x00000000
    .long 0x00000000, 0x00000000, 0x00000000, 0x00000000
    .long 0x00000000, 0x00000000, 0x00000000, 0x00000000
    .long 0x00000000, 0x00000000, 0x00000000, 0x00000000
    .long 0x00000000, 0x00000000, 0x00000000, 0x00000000
    .long 0x00000000, 0x00000000, 0x00000000, 0x00000000
    .long 0x00000000, 0x00000000, 0x00000000, 0x00000000
    .long 0x00000000, 0x00000000, 0x00000000, 0x00000000
    .long 0x00003f80, 0x00000000, 0x00000000, 0x00000000
    .long 0x3f803f80, 0x00000000, 0x00000000, 0x00000000
    .long 0x3f803f80, 0x00003f80, 0x00000000, 0x00000000
    .long 0x3f803f80, 0x3f803f80, 0x00000000, 0x00000000
    .long 0x3f803f80, 0x3f803f80, 0x00003f80, 0x00000000
    .long 0x3f803f80, 0x3f803f80, 0x3f803f80, 0x00000000
    .long 0x3f803f80, 0x3f803f80, 0x3f803f80, 0x00003f80
    .long 0x3f803f80, 0x3f803f80, 0x3f803f80, 0x3f803f80
    .long 0x3f803f80, 0x3f803f80, 0x3f803f80, 0x3f803f80
    .long 0x3f800000, 0x3f803f80, 0x3f803f80, 0x3f803f80
    .long 0x00000000, 0x3f803f80, 0x3f803f80, 0x3f803f80
    .long 0x00000000, 0x3f800000, 0x3f803f80, 0x3f803f80
    .long 0x00000000, 0x00000000, 0x00000000, 0x00000000
    .long 0x00000000, 0x00000000, 0x00000000, 0x00000000
    .long 0x00000000, 0x00000000, 0x00000000, 0x00000000
    .long 0x00000000, 0x00000000, 0x00000000, 0x00000000
    .long 0x00000000, 0x00000000, 0x00000000, 0x00000000
    .long 0x00000000, 0x00000000, 0x00000000, 0x00000000
    .long 0x00000000, 0x00000000, 0x00000000, 0x00000000
    .long 0x00000000, 0x00000000, 0x00000000, 0x00000000
    .long 0x00000000, 0x00000000, 0x00000000, 0x00000000
    .long 0x00000000, 0x00000000, 0x00000000, 0x00000000
    .long 0x00000000, 0x00000000, 0x00000000, 0x00000000
    .long 0x00000000, 0x00000000, 0x00000000, 0x00000000
    .long 0x00003f80, 0x00000000, 0x00000000, 0x00000000
    .long 0x3f803f80, 0x00000000, 0x00000000, 0x00000000
    .long 0x3f803f80, 0x00003f80, 0x00000000, 0x00000000
    .long 0x3f803f80, 0x3f803f80, 0x00000000, 0x00000000
    .long 0x00000000, 0x00000000, 0x3f800000, 0x3f803f80
    .long 0x00000000, 0x00000000, 0x00000000, 0x3f803f80
    .long 0x00000000, 0x00000000, 0x00000000, 0x3f800000
    .long 0x00000000, 0x00000000, 0x00000000, 0x00000000
    .long 0x00000000, 0x00000000, 0x00000000, 0x00000000
    .long 0x00000000, 0x00000000, 0x00000000, 0x00000000
    .long 0x00000000, 0x00000000, 0x00000000, 0x00000000
    .long 0x00000000, 0x00000000, 0x00000000, 0x00000000
    .long 0x00000000, 0x00000000, 0x00000000, 0x00000000
    .long 0x00000000, 0x00000000, 0x00000000, 0x00000000
    .long 0x00000000, 0x00000000, 0x00000000, 0x00000000
    .long 0x00000000, 0x00000000, 0x00000000, 0x00000000
    .long 0x00000000, 0x00000000, 0x00000000, 0x00000000
    .long 0x00000000, 0x00000000, 0x00000000, 0x00000000
    .long 0x00000000, 0x00000000, 0x00000000, 0x00000000
    .long 0x00000000, 0x00000000, 0x00000000, 0x00000000
    .long 0x3f803f80, 0x3f803f80, 0x00000000, 0x00000000
    .long 0x3f803f80, 0x3f803f80, 0x00003f80, 0x00000000
    .long 0x3f803f80, 0x3f803f80, 0x3f803f80, 0x00000000
    .long 0x3f803f80, 0x3f803f80, 0x3f803f80, 0x00003f80
    .long 0x3f800000, 0x3f803f80, 0x3f803f80, 0x3f803f80
    .long 0x00000000, 0x3f803f80, 0x3f803f80, 0x3f803f80
    .long 0x00000000, 0x3f800000, 0x3f803f80, 0x3f803f80
    .long 0x00000000, 0x00000000, 0x3f803f80, 0x3f803f80
    .long 0x00000000, 0x00000000, 0x3f800000, 0x3f803f80
    .long 0x00000000, 0x00000000, 0x00000000, 0x3f803f80
    .long 0x00000000, 0x00000000, 0x00000000, 0x3f800000
    .long 0x00000000, 0x00000000, 0x00000000, 0x00000000
    .long 0x00000000, 0x00000000, 0x00000000, 0x00000000
    .long 0x00000000, 0x00000000, 0x00000000, 0x00000000
    .long 0x00000000, 0x00000000, 0x00000000, 0x00000000
    .long 0x00000000, 0x00000000, 0x00000000, 0x00000000
    .long 0x00000000, 0x00000000, 0x00000000, 0x00000000
    .long 0x00000000, 0x00000000, 0x00000000, 0x00000000
    .long 0x00000000, 0x00000000, 0x00000000, 0x00000000
    .long 0x00000000, 0x00000000, 0x00000000, 0x00000000
    .long 0x00000000, 0x00000000, 0x00000000, 0x00000000
    .long 0x00003f80, 0x00000000, 0x00000000, 0x00000000
    .long 0x3f803f80, 0x00000000, 0x00000000, 0x00000000
    .long 0x3f803f80, 0x00003f80, 0x00000000, 0x00000000
    .long 0x3f803f80, 0x3f803f80, 0x00000000, 0x00000000
    .long 0x3f803f80, 0x3f803f80, 0x00003f80, 0x00000000
    .long 0x3f803f80, 0x3f803f80, 0x3f803f80, 0x00000000
    .long 0x3f803f80, 0x3f803f80, 0x3f803f80, 0x00003f80
    .long 0x3f800000, 0x3f803f80, 0x3f803f80, 0x3f803f80
    .long 0x00000000, 0x3f803f80, 0x3f803f80, 0x3f803f80
    .long 0x00000000, 0x3f800000, 0x3f803f80, 0x3f803f80
    .long 0x00000000, 0x00000000, 0x3f803f80, 0x3f803f80
    .long 0x00000000, 0x00000000, 0x00000000, 0x00000000
    .long 0x00000000, 0x00000000, 0x00000000, 0x00000000
    .long 0x00000000, 0x00000000, 0x00000000, 0x00000000
    .long 0x00000000, 0x00000000, 0x00000000, 0x00000000
    .long 0x00000000, 0x00000000, 0x00000000, 0x00000000
    .long 0x00000000, 0x00000000, 0x00000000, 0x00000000
    .long 0x00000000, 0x00000000, 0x00000000, 0x00000000
    .long 0x00000000, 0x00000000, 0x00000000, 0x00000000
    .long 0x00000000, 0x00000000, 0x00000000, 0x00000000
    .long 0x00000000, 0x00000000, 0x00000000, 0x00000000
    .long 0x00000000, 0x00000000, 0x00000000, 0x00000000
    .long 0x00000000, 0x00000000, 0x00000000, 0x00000000
    .long 0x00000000, 0x00000000, 0x00000000, 0x00000000
    .long 0x00003f80, 0x00000000, 0x00000000, 0x00000000
    .long 0x3f803f80, 0x00000000, 0x00000000, 0x00000000
    .long 0x3f803f80, 0x00003f80, 0x00000000, 0x00000000
.size L_TAB, 6144
L_LAST:
.section .rodata,"a"
.p2align 6
.amdhsa_kernel concat_heads__ssm_conv_s4d__ssm_conv_h3__prompt_kernel
  .amdhsa_next_free_vgpr 256
  .amdhsa_next_free_sgpr 102
  .amdhsa_accum_offset 256
  .amdhsa_group_segment_fixed_size 0
  .amdhsa_kernarg_size 128
  .amdhsa_user_sgpr_count 2
  .amdhsa_user_sgpr_kernarg_segment_ptr 1
  .amdhsa_system_sgpr_workgroup_id_x 1
  .amdhsa_float_denorm_mode_32 3
.end_amdhsa_kernel
```
